```python
import torch

def _softmax(x, axis=-1):
    return torch.softmax(x, dim=axis)
def _gelu(x):
    return torch.nn.functional.gelu(x, approximate="tanh")
def _silu(x):
    return torch.nn.functional.silu(x)
def _sigmoid(x):
    return torch.sigmoid(x)
def _layernorm(x, axis=-1, eps=1e-5):
    m = x.mean(dim=axis, keepdim=True)
    v = x.var(dim=axis, keepdim=True, unbiased=False)
    return (x - m) / torch.sqrt(v + eps)
def _scatter_add(tgt, idx, src, axis=0):
    return tgt.clone().index_add_(axis, idx, src)
def _segment_sum(src, seg, n):
    out = torch.zeros((n,) + src.shape[1:], dtype=src.dtype)
    return out.index_add_(0, seg, src)
def _pad(x, pw):
    flat = tuple(v for pair in reversed(pw) for v in pair)
    return torch.nn.functional.pad(x, flat)

kernel_name = 'parallel_sum__gqa_block_cached__dense_activation_squared_relu__decode'

def setup_inputs():

    _w = (lambda a: (lambda t: t.to(torch.bfloat16) if t.is_floating_point() else t)(torch.as_tensor(a)))
    def _A_setup():
        B, Sq, D = 2, 1, 1024
        Hq, Hkv, Sk, Dh = 32, 4, 32768, 128
        assert Hq % Hkv == 0, (Hq, Hkv)
        return {
            "x": _w((lambda *s: torch.randn(*s, dtype=torch.bfloat16) * 0.05)(B, Sq, D)),
            "k_cache": _w((lambda *s: torch.randn(*s, dtype=torch.bfloat16) * 3.2)(B, Hkv, Sk, Dh)),
            "v_cache": _w((lambda *s: torch.randn(*s, dtype=torch.bfloat16) * 3.2)(B, Hkv, Sk, Dh)),
            "wq": _w((lambda *s: torch.randn(*s, dtype=torch.bfloat16) * 3.2)(D, Hq * Dh) * (D ** -0.5)),
            "wo": _w((lambda *s: torch.randn(*s, dtype=torch.bfloat16) * 3.2)(Hq * Dh, D) * ((Hq * Dh) ** -0.5)),
        }
    _A_in = _A_setup()

    def _B_setup():
        B, S, D, F = 2, 1, 1024, 3584
        return {
            "x": _w((lambda *s: torch.randn(*s, dtype=torch.bfloat16) * 0.05)(B, S, D)),
            "w1": _w((lambda *s: torch.randn(*s, dtype=torch.bfloat16) * 0.05)(D, F)),
            "b1": _w((lambda *s: torch.randn(*s, dtype=torch.bfloat16) * 0.8)(F)),
            "w2": _w((lambda *s: torch.randn(*s, dtype=torch.bfloat16) * 0.05)(F, D)),
            "b2": _w((lambda *s: torch.randn(*s, dtype=torch.bfloat16) * 6.4)(D)),
        }
    _B_in = _B_setup()

    return {
        "A_x": _A_in["x"],
        "A_k_cache": _A_in["k_cache"],
        "A_v_cache": _A_in["v_cache"],
        "A_wq": _A_in["wq"],
        "A_wo": _A_in["wo"],
        "B_x": _B_in["x"],
        "B_w1": _B_in["w1"],
        "B_b1": _B_in["b1"],
        "B_w2": _B_in["w2"],
        "B_b2": _B_in["b2"],
    }

def reference(A_x, A_k_cache, A_v_cache, A_wq, A_wo, B_x, B_w1, B_b1, B_w2, B_b2):
    def _A_ref(x, k_cache, v_cache, wq, wo):
        B, Sq, D = x.shape
        Hq, Dh = 32, 128
        Hkv = k_cache.shape[1]
        rep = Hq // Hkv
        q = (lambda x, *d: x.permute(*d))((x @ wq).reshape(B, Sq, Hq, Dh), 0, 2, 1, 3)
        k = (lambda x, n, axis: torch.repeat_interleave(x, n, dim=axis))(k_cache, rep, axis=1)
        v = (lambda x, n, axis: torch.repeat_interleave(x, n, dim=axis))(v_cache, rep, axis=1)
        scores = torch.einsum("bhqd,bhkd->bhqk", q, k) * (Dh ** -0.5)
        p = _softmax(scores, axis=-1)
        o = torch.einsum("bhqk,bhkd->bhqd", p, v)
        return (lambda x, *d: x.permute(*d))(o, 0, 2, 1, 3).reshape(B, Sq, Hq * Dh) @ wo

    def _B_ref(x, w1, b1, w2, b2):
        h = torch.einsum("bsd,df->bsf", x, w1) + b1
        zero = torch.zeros_like(h)
        r = torch.where(h > zero, h, zero)
        h = r * r
        out = torch.einsum("bsf,fd->bsd", h, w2) + b2
        return out

    x = A_x
    xn = _layernorm(x, axis=-1)
    return x + _A_ref(xn, A_k_cache, A_v_cache, A_wq, A_wo) + _B_ref(xn, B_w1, B_b1, B_w2, B_b2)
```

```asm
; @launch grid=(256,1,1) block=(512,1,1) lds=52480
.amdgcn_target "amdgcn-amd-amdhsa--gfx950"
.text
.globl parallel_sum__gqa_block_cached__dense_activation_squared_relu__decode_kernel
.p2align 8
.type parallel_sum__gqa_block_cached__dense_activation_squared_relu__decode_kernel,@function
parallel_sum__gqa_block_cached__dense_activation_squared_relu__decode_kernel:
    s_cmp_ge_u32 s2, 0x100
    s_cbranch_scc1 L_END
    s_load_dwordx8 s[4:11], s[0:1], 0
    s_load_dwordx8 s[12:19], s[0:1], 32
    s_load_dwordx8 s[20:27], s[0:1], 64
    s_load_dwordx2 s[28:29], s[0:1], 96
    v_lshrrev_b32 v1, 6, v0
    v_and_b32 v0, 63, v0
    v_readfirstlane_b32 s72, v1
    v_and_b32 v5, 15, v0
    v_lshrrev_b32 v6, 4, v0
    v_and_b32 v10, 1, v0
    v_lshlrev_b32 v10, 11, v10
    v_lshrrev_b32 v11, 1, v0
    v_lshl_add_u32 v28, v11, 4, v10
    v_lshl_add_u32 v29, v6, 4, v10
    s_and_b32 s74, s2, 3
    s_lshl_b32 s74, s74, 8
    s_lshl_b32 s75, s72, 5
    s_add_u32 s74, s74, s75
    s_lshl_b32 s95, s74, 1
    s_cmp_lt_u32 s2, 0x80
    s_movk_i32 s76, 0x1c00
    s_cselect_b32 s76, 0x2000, s76
    s_mul_i32 s74, s74, s76
    s_lshr_b32 s75, s2, 2
    s_and_b32 s75, s75, 31
    s_lshl_b32 s87, s75, 8
    s_add_u32 s74, s74, s87
    s_lshl_b32 s87, s76, 3
    v_lshlrev_b32 v3, 4, v5
    v_mad_u32_u24 v3, v6, s87, v3
    s_waitcnt lgkmcnt(0)
    s_mov_b32 s32, s4
    s_mov_b32 s33, s5
    s_mov_b32 s34, 0x1000
    s_mov_b32 s35, 0x20000
    buffer_load_dwordx4 v[8:11], v28, s[32:35], 0 offen offset:0
    buffer_load_dwordx4 v[12:15], v28, s[32:35], 0 offen offset:512
    buffer_load_dwordx4 v[16:19], v28, s[32:35], 0 offen offset:1024
    buffer_load_dwordx4 v[20:23], v28, s[32:35], 0 offen offset:1536
    buffer_load_dwordx4 v[24:27], v29, s[32:35], s95 offen
    s_cmp_lt_u32 s2, 0x80
    s_cselect_b32 s44, s10, s16
    s_cselect_b32 s45, s11, s17
    s_mov_b32 s46, 0x700000
    s_cselect_b32 s46, 0x800000, s46
    s_cmp_lt_u32 s2, 240
    s_cselect_b32 s46, s46, 0
    s_mov_b32 s47, 0x20000
    buffer_load_dwordx4 v[192:195], v3, s[44:47], s74 offen nt
    s_add_u32 s74, s74, s76
    buffer_load_dwordx4 v[196:199], v3, s[44:47], s74 offen nt
    s_add_u32 s74, s74, s76
    buffer_load_dwordx4 v[200:203], v3, s[44:47], s74 offen nt
    s_add_u32 s74, s74, s76
    buffer_load_dwordx4 v[204:207], v3, s[44:47], s74 offen nt
    s_add_u32 s74, s74, s76
    buffer_load_dwordx4 v[208:211], v3, s[44:47], s74 offen nt
    s_add_u32 s74, s74, s76
    buffer_load_dwordx4 v[212:215], v3, s[44:47], s74 offen nt
    s_add_u32 s74, s74, s76
    buffer_load_dwordx4 v[216:219], v3, s[44:47], s74 offen nt
    s_add_u32 s74, s74, s76
    buffer_load_dwordx4 v[220:223], v3, s[44:47], s74 offen nt
    s_mov_b32 s52, s28
    s_mov_b32 s53, s29
    s_mov_b32 s54, 0x400000
    s_mov_b32 s55, 0x20000
    s_cmp_lg_u32 s72, 7
    s_cbranch_scc1 L_NOEP
    s_mov_b64 exec, 1
    s_mov_b32 s74, 0x90000
    buffer_load_dword v30, off, s[52:55], s74 sc1
    s_mov_b64 exec, -1
L_NOEP:
    s_mov_b32 s36, s6
    s_mov_b32 s37, s7
    s_mov_b32 s38, 0x4000000
    s_mov_b32 s39, 0x20000
    s_mov_b32 s40, s8
    s_mov_b32 s41, s9
    s_mov_b32 s42, 0x4000000
    s_mov_b32 s43, 0x20000
    s_mov_b32 s4, s26
    s_mov_b32 s5, s27
    s_mov_b32 s6, 0x100
    s_mov_b32 s7, 0x20000
    s_and_b32 s74, s2, 7
    s_lshl_b32 s73, s74, 23
    s_lshr_b32 s94, s2, 3
    s_lshl_b32 s75, s94, 18
    s_add_u32 s73, s73, s75
    s_lshl_b32 s75, s72, 15
    s_add_u32 s73, s73, s75
    v_and_b32 v28, 3, v5
    v_lshlrev_b32 v28, 10, v28
    v_bfe_u32 v29, v5, 2, 1
    v_lshl_add_u32 v28, v29, 8, v28
    v_lshrrev_b32 v29, 3, v5
    v_lshl_add_u32 v28, v29, 6, v28
    v_and_b32 v28, 1, v5
    v_lshlrev_b32 v28, 10, v28
    v_bfe_u32 v29, v5, 1, 1
    v_lshl_add_u32 v28, v29, 9, v28
    v_bfe_u32 v29, v5, 2, 1
    v_lshl_add_u32 v28, v29, 8, v28
    v_lshrrev_b32 v29, 3, v5
    v_lshl_add_u32 v28, v29, 6, v28
    v_lshl_add_u32 v1, v6, 4, v28
    v_lshlrev_b32 v2, 4, v0
    s_add_u32 s74, s73, 0
    buffer_load_dwordx4 v[32:35], v1, s[36:39], s74 offen offset:0 nt
    buffer_load_dwordx4 v[36:39], v1, s[36:39], s74 offen offset:128 nt
    buffer_load_dwordx4 v[40:43], v1, s[36:39], s74 offen offset:2048 nt
    buffer_load_dwordx4 v[44:47], v1, s[36:39], s74 offen offset:2176 nt
    s_and_b32 s75, s2, 7
    s_lshl_b32 s84, s75, 17
    s_lshl_b32 s95, s94, 9
    s_add_u32 s84, s84, s95
    s_add_u32 s84, s84, 0x100000
    s_lshl_b32 s85, s75, 12
    s_lshl_b32 s95, s94, 4
    s_add_u32 s85, s85, s95
    s_add_u32 s85, s85, 0x200000
    s_mov_b32 s77, 0x05040100
    s_mov_b32 s78, 0x07060302
    s_mov_b32 s80, 0x00030003
    s_mov_b32 s81, 0x00030003
    s_mov_b32 s82, 0x00ff00ff
    s_mov_b32 s83, 0x00ff00ff
    s_mov_b32 s88, 0x3db504f3
    s_mov_b32 s89, 0x3fb8aa3b
    s_mov_b32 s90, 0xffff0000
    s_mov_b32 s92, 0x0c0c0400
    s_mov_b32 s93, 0x04000c0c
    s_mov_b32 s60, s24
    s_mov_b32 s61, s25
    s_mov_b32 s62, 0x1000
    s_mov_b32 s63, 0x20000
    s_mov_b32 s64, s18
    s_mov_b32 s65, s19
    s_mov_b32 s66, 0x1c00
    s_mov_b32 s67, 0x20000
    s_mov_b32 s68, s22
    s_mov_b32 s69, s23
    s_mov_b32 s70, 0x800
    s_mov_b32 s71, 0x20000
    s_cmp_lt_u32 s72, 4
    s_cselect_b32 s48, s12, s20
    s_cselect_b32 s49, s13, s21
    s_mov_b32 s50, 0x800000
    s_mov_b32 s51, 0x20000
    v_lshlrev_b32 v4, 4, v5
    v_lshl_add_u32 v4, v6, 12, v4
    v_mov_b32 v3, 0xff
    s_waitcnt vmcnt(13)
    v_lshlrev_b32 v224, 16, v8
    v_and_b32 v225, s90, v8
    v_lshlrev_b32 v226, 16, v9
    v_and_b32 v227, s90, v9
    v_lshlrev_b32 v228, 16, v10
    v_and_b32 v229, s90, v10
    v_lshlrev_b32 v230, 16, v11
    v_and_b32 v231, s90, v11
    v_lshlrev_b32 v232, 16, v12
    v_and_b32 v233, s90, v12
    v_lshlrev_b32 v234, 16, v13
    v_and_b32 v235, s90, v13
    v_lshlrev_b32 v236, 16, v14
    v_and_b32 v237, s90, v14
    v_lshlrev_b32 v238, 16, v15
    v_and_b32 v239, s90, v15
    v_lshlrev_b32 v240, 16, v16
    v_and_b32 v241, s90, v16
    v_lshlrev_b32 v242, 16, v17
    v_and_b32 v243, s90, v17
    v_lshlrev_b32 v244, 16, v18
    v_and_b32 v245, s90, v18
    v_lshlrev_b32 v246, 16, v19
    v_and_b32 v247, s90, v19
    v_lshlrev_b32 v248, 16, v20
    v_and_b32 v249, s90, v20
    v_lshlrev_b32 v250, 16, v21
    v_and_b32 v251, s90, v21
    v_lshlrev_b32 v252, 16, v22
    v_and_b32 v253, s90, v22
    v_lshlrev_b32 v254, 16, v23
    v_and_b32 v255, s90, v23
    v_add_f32 v8, v224, v228
    v_add_f32 v9, v225, v229
    v_add_f32 v10, v226, v230
    v_add_f32 v11, v227, v231
    v_add_f32 v8, v8, v232
    v_add_f32 v9, v9, v233
    v_add_f32 v10, v10, v234
    v_add_f32 v11, v11, v235
    v_add_f32 v8, v8, v236
    v_add_f32 v9, v9, v237
    v_add_f32 v10, v10, v238
    v_add_f32 v11, v11, v239
    v_add_f32 v8, v8, v240
    v_add_f32 v9, v9, v241
    v_add_f32 v10, v10, v242
    v_add_f32 v11, v11, v243
    v_add_f32 v8, v8, v244
    v_add_f32 v9, v9, v245
    v_add_f32 v10, v10, v246
    v_add_f32 v11, v11, v247
    v_add_f32 v8, v8, v248
    v_add_f32 v9, v9, v249
    v_add_f32 v10, v10, v250
    v_add_f32 v11, v11, v251
    v_add_f32 v8, v8, v252
    v_add_f32 v9, v9, v253
    v_add_f32 v10, v10, v254
    v_add_f32 v11, v11, v255
    v_add_f32 v8, v8, v9
    v_add_f32 v10, v10, v11
    v_add_f32 v8, v8, v10
    s_nop 1
    v_add_f32_dpp v8, v8, v8 row_ror:2 row_mask:0xf bank_mask:0xf
    s_nop 1
    v_add_f32_dpp v8, v8, v8 row_ror:4 row_mask:0xf bank_mask:0xf
    s_nop 1
    v_add_f32_dpp v8, v8, v8 row_ror:8 row_mask:0xf bank_mask:0xf
    v_mov_b32 v9, v8
    s_nop 1
    v_permlane16_swap_b32 v8, v9
    v_add_f32 v8, v8, v9
    v_mov_b32 v9, v8
    s_nop 1
    v_permlane32_swap_b32 v8, v9
    v_add_f32 v8, v8, v9
    v_mul_f32 v12, 0x3a800000, v8
    v_sub_f32 v224, v224, v12
    v_sub_f32 v225, v225, v12
    v_sub_f32 v226, v226, v12
    v_sub_f32 v227, v227, v12
    v_sub_f32 v228, v228, v12
    v_sub_f32 v229, v229, v12
    v_sub_f32 v230, v230, v12
    v_sub_f32 v231, v231, v12
    v_sub_f32 v232, v232, v12
    v_sub_f32 v233, v233, v12
    v_sub_f32 v234, v234, v12
    v_sub_f32 v235, v235, v12
    v_sub_f32 v236, v236, v12
    v_sub_f32 v237, v237, v12
    v_sub_f32 v238, v238, v12
    v_sub_f32 v239, v239, v12
    v_sub_f32 v240, v240, v12
    v_sub_f32 v241, v241, v12
    v_sub_f32 v242, v242, v12
    v_sub_f32 v243, v243, v12
    v_sub_f32 v244, v244, v12
    v_sub_f32 v245, v245, v12
    v_sub_f32 v246, v246, v12
    v_sub_f32 v247, v247, v12
    v_sub_f32 v248, v248, v12
    v_sub_f32 v249, v249, v12
    v_sub_f32 v250, v250, v12
    v_sub_f32 v251, v251, v12
    v_sub_f32 v252, v252, v12
    v_sub_f32 v253, v253, v12
    v_sub_f32 v254, v254, v12
    v_sub_f32 v255, v255, v12
    v_mul_f32 v8, v224, v224
    v_mul_f32 v9, v225, v225
    v_mul_f32 v10, v226, v226
    v_mul_f32 v11, v227, v227
    v_fmac_f32 v8, v228, v228
    v_fmac_f32 v9, v229, v229
    v_fmac_f32 v10, v230, v230
    v_fmac_f32 v11, v231, v231
    v_fmac_f32 v8, v232, v232
    v_fmac_f32 v9, v233, v233
    v_fmac_f32 v10, v234, v234
    v_fmac_f32 v11, v235, v235
    v_fmac_f32 v8, v236, v236
    v_fmac_f32 v9, v237, v237
    v_fmac_f32 v10, v238, v238
    v_fmac_f32 v11, v239, v239
    v_fmac_f32 v8, v240, v240
    v_fmac_f32 v9, v241, v241
    v_fmac_f32 v10, v242, v242
    v_fmac_f32 v11, v243, v243
    v_fmac_f32 v8, v244, v244
    v_fmac_f32 v9, v245, v245
    v_fmac_f32 v10, v246, v246
    v_fmac_f32 v11, v247, v247
    v_fmac_f32 v8, v248, v248
    v_fmac_f32 v9, v249, v249
    v_fmac_f32 v10, v250, v250
    v_fmac_f32 v11, v251, v251
    v_fmac_f32 v8, v252, v252
    v_fmac_f32 v9, v253, v253
    v_fmac_f32 v10, v254, v254
    v_fmac_f32 v11, v255, v255
    v_add_f32 v8, v8, v9
    v_add_f32 v10, v10, v11
    v_add_f32 v8, v8, v10
    s_nop 1
    v_add_f32_dpp v8, v8, v8 row_ror:2 row_mask:0xf bank_mask:0xf
    s_nop 1
    v_add_f32_dpp v8, v8, v8 row_ror:4 row_mask:0xf bank_mask:0xf
    s_nop 1
    v_add_f32_dpp v8, v8, v8 row_ror:8 row_mask:0xf bank_mask:0xf
    v_mov_b32 v9, v8
    s_nop 1
    v_permlane16_swap_b32 v8, v9
    v_add_f32 v8, v8, v9
    v_mov_b32 v9, v8
    s_nop 1
    v_permlane32_swap_b32 v8, v9
    v_add_f32 v8, v8, v9
    v_mul_f32 v8, 0x3a800000, v8
    v_cvt_pk_bf16_f32 v9, v12, v8
    v_lshlrev_b32 v12, 16, v9
    v_and_b32 v8, s90, v9
    v_add_f32 v8, 0x3727c5ac, v8
    v_cvt_pk_bf16_f32 v8, v8, v8
    v_and_b32 v8, s90, v8
    v_sqrt_f32 v8, v8
    s_nop 0
    v_cvt_pk_bf16_f32 v8, v8, v8
    v_and_b32 v8, s90, v8
    v_rcp_f32 v9, v8
    s_waitcnt vmcnt(12)
    v_lshlrev_b32 v224, 16, v24
    v_and_b32 v225, s90, v24
    v_lshlrev_b32 v226, 16, v25
    v_and_b32 v227, s90, v25
    v_lshlrev_b32 v228, 16, v26
    v_and_b32 v229, s90, v26
    v_lshlrev_b32 v230, 16, v27
    v_and_b32 v231, s90, v27
    v_sub_f32 v224, v224, v12
    v_sub_f32 v225, v225, v12
    v_sub_f32 v226, v226, v12
    v_sub_f32 v227, v227, v12
    v_sub_f32 v228, v228, v12
    v_sub_f32 v229, v229, v12
    v_sub_f32 v230, v230, v12
    v_sub_f32 v231, v231, v12
    v_cvt_pk_bf16_f32 v24, v224, v225
    v_cvt_pk_bf16_f32 v25, v226, v227
    v_cvt_pk_bf16_f32 v26, v228, v229
    v_cvt_pk_bf16_f32 v27, v230, v231
    v_lshlrev_b32 v224, 16, v24
    v_and_b32 v225, s90, v24
    v_lshlrev_b32 v226, 16, v25
    v_and_b32 v227, s90, v25
    v_lshlrev_b32 v228, 16, v26
    v_and_b32 v229, s90, v26
    v_lshlrev_b32 v230, 16, v27
    v_and_b32 v231, s90, v27
    v_mul_f32 v232, v224, v9
    v_mul_f32 v233, v225, v9
    v_mul_f32 v234, v226, v9
    v_mul_f32 v235, v227, v9
    v_mul_f32 v236, v228, v9
    v_mul_f32 v237, v229, v9
    v_mul_f32 v238, v230, v9
    v_mul_f32 v239, v231, v9
    v_fma_f32 v224, -v232, v8, v224
    v_fma_f32 v225, -v233, v8, v225
    v_fma_f32 v226, -v234, v8, v226
    v_fma_f32 v227, -v235, v8, v227
    v_fma_f32 v228, -v236, v8, v228
    v_fma_f32 v229, -v237, v8, v229
    v_fma_f32 v230, -v238, v8, v230
    v_fma_f32 v231, -v239, v8, v231
    v_fmac_f32 v232, v224, v9
    v_fmac_f32 v233, v225, v9
    v_fmac_f32 v234, v226, v9
    v_fmac_f32 v235, v227, v9
    v_fmac_f32 v236, v228, v9
    v_fmac_f32 v237, v229, v9
    v_fmac_f32 v238, v230, v9
    v_fmac_f32 v239, v231, v9
    v_cvt_pk_bf16_f32 v24, v232, v233
    v_cvt_pk_bf16_f32 v25, v234, v235
    v_cvt_pk_bf16_f32 v26, v236, v237
    v_cvt_pk_bf16_f32 v27, v238, v239
    v_lshlrev_b32 v29, 9, v5
    v_lshl_add_u32 v29, v6, 7, v29
    s_lshl_b32 s74, s72, 10
    v_add_u32 v29, s74, v29
    s_waitcnt vmcnt(4)
    s_add_u32 s74, s73, 4096
    buffer_load_dwordx4 v[48:51], v1, s[36:39], s74 offen offset:0 nt
    buffer_load_dwordx4 v[52:55], v1, s[36:39], s74 offen offset:128 nt
    buffer_load_dwordx4 v[56:59], v1, s[36:39], s74 offen offset:2048 nt
    buffer_load_dwordx4 v[60:63], v1, s[36:39], s74 offen offset:2176 nt
    v_perm_b32 v8, v196, v192, s77
    v_perm_b32 v9, v204, v200, s77
    v_perm_b32 v10, v212, v208, s77
    v_perm_b32 v11, v220, v216, s77
    v_perm_b32 v12, v196, v192, s78
    v_perm_b32 v13, v204, v200, s78
    v_perm_b32 v14, v212, v208, s78
    v_perm_b32 v15, v220, v216, s78
    v_mfma_f32_16x16x32_bf16 v[224:227], v[8:11], v[24:27], 0
    v_perm_b32 v16, v197, v193, s77
    v_perm_b32 v17, v205, v201, s77
    v_perm_b32 v18, v213, v209, s77
    v_perm_b32 v19, v221, v217, s77
    v_mfma_f32_16x16x32_bf16 v[228:231], v[12:15], v[24:27], 0
    v_perm_b32 v20, v197, v193, s78
    v_perm_b32 v21, v205, v201, s78
    v_perm_b32 v22, v213, v209, s78
    v_perm_b32 v23, v221, v217, s78
    v_mfma_f32_16x16x32_bf16 v[232:235], v[16:19], v[24:27], 0
    v_perm_b32 v8, v198, v194, s77
    v_perm_b32 v9, v206, v202, s77
    v_perm_b32 v10, v214, v210, s77
    v_perm_b32 v11, v222, v218, s77
    v_mfma_f32_16x16x32_bf16 v[236:239], v[20:23], v[24:27], 0
    v_perm_b32 v12, v198, v194, s78
    v_perm_b32 v13, v206, v202, s78
    v_perm_b32 v14, v214, v210, s78
    v_perm_b32 v15, v222, v218, s78
    v_mfma_f32_16x16x32_bf16 v[240:243], v[8:11], v[24:27], 0
    v_perm_b32 v16, v199, v195, s77
    v_perm_b32 v17, v207, v203, s77
    v_perm_b32 v18, v215, v211, s77
    v_perm_b32 v19, v223, v219, s77
    v_mfma_f32_16x16x32_bf16 v[244:247], v[12:15], v[24:27], 0
    v_perm_b32 v20, v199, v195, s78
    v_perm_b32 v21, v207, v203, s78
    v_perm_b32 v22, v215, v211, s78
    v_perm_b32 v23, v223, v219, s78
    v_mfma_f32_16x16x32_bf16 v[248:251], v[16:19], v[24:27], 0
    s_nop 0
    v_mfma_f32_16x16x32_bf16 v[252:255], v[20:23], v[24:27], 0
    s_mov_b64 exec, s[80:81]
    ds_write_b128 v29, v[224:227] offset:0
    ds_write_b128 v29, v[228:231] offset:16
    ds_write_b128 v29, v[232:235] offset:32
    ds_write_b128 v29, v[236:239] offset:48
    ds_write_b128 v29, v[240:243] offset:64
    ds_write_b128 v29, v[244:247] offset:80
    ds_write_b128 v29, v[248:251] offset:96
    ds_write_b128 v29, v[252:255] offset:112
    s_mov_b64 exec, -1
    s_cmp_lg_u32 s72, 7
    s_nop 2
    s_cbranch_scc1 L_B1
    s_mov_b64 exec, 1
    v_mov_b32 v29, 0
    ds_write_b32 v29, v30 offset:10880
    s_mov_b64 exec, -1
L_B1:
    s_waitcnt lgkmcnt(0)
    s_barrier
    v_mov_b32 v29, 0
    ds_read_b32 v30, v29 offset:10880
    s_cmp_ge_u32 s72, 4
    s_cbranch_scc1 L_SVC
    s_cmp_lg_u32 s72, 0
    s_cbranch_scc1 L_A1
    ds_read_b128 v[224:227], v2 offset:0
    ds_read_b128 v[228:231], v2 offset:1024
    ds_read_b128 v[232:235], v2 offset:2048
    ds_read_b128 v[236:239], v2 offset:3072
    ds_read_b128 v[240:243], v2 offset:4096
    ds_read_b128 v[244:247], v2 offset:5120
    ds_read_b128 v[248:251], v2 offset:6144
    ds_read_b128 v[252:255], v2 offset:7168
    s_waitcnt lgkmcnt(8)
    v_readfirstlane_b32 s91, v30
    s_nop 0
    s_add_u32 s91, s91, 1
    s_mul_i32 s56, s91, 0x9e3779b1
    s_lshr_b32 s57, s56, 8
    s_lshr_b32 s58, s56, 16
    s_lshr_b32 s59, s56, 24
    s_waitcnt lgkmcnt(0)
    v_pk_add_f32 v[224:225], v[224:225], v[240:241]
    v_pk_add_f32 v[226:227], v[226:227], v[242:243]
    v_pk_add_f32 v[228:229], v[228:229], v[244:245]
    v_pk_add_f32 v[230:231], v[230:231], v[246:247]
    v_pk_add_f32 v[232:233], v[232:233], v[248:249]
    v_pk_add_f32 v[234:235], v[234:235], v[250:251]
    v_pk_add_f32 v[236:237], v[236:237], v[252:253]
    v_pk_add_f32 v[238:239], v[238:239], v[254:255]
    v_pk_add_f32 v[224:225], v[224:225], v[232:233]
    v_pk_add_f32 v[226:227], v[226:227], v[234:235]
    v_pk_add_f32 v[228:229], v[228:229], v[236:237]
    v_pk_add_f32 v[230:231], v[230:231], v[238:239]
    v_pk_add_f32 v[224:225], v[224:225], v[228:229]
    v_pk_add_f32 v[226:227], v[226:227], v[230:231]
    v_bfi_b32 v224, v3, s56, v224
    v_bfi_b32 v225, v3, s57, v225
    v_bfi_b32 v226, v3, s58, v226
    v_bfi_b32 v227, v3, s59, v227
    s_lshl_b32 s74, s2, 10
    buffer_store_dwordx4 v[224:227], v2, s[52:55], s74 offen sc1
L_A1:
    s_add_u32 s74, s73, 8192
    buffer_load_dwordx4 v[64:67], v1, s[36:39], s74 offen offset:0 nt
    buffer_load_dwordx4 v[68:71], v1, s[36:39], s74 offen offset:128 nt
    buffer_load_dwordx4 v[72:75], v1, s[36:39], s74 offen offset:2048 nt
    buffer_load_dwordx4 v[76:79], v1, s[36:39], s74 offen offset:2176 nt
    s_add_u32 s74, s73, 12288
    buffer_load_dwordx4 v[80:83], v1, s[36:39], s74 offen offset:0 nt
    buffer_load_dwordx4 v[84:87], v1, s[36:39], s74 offen offset:128 nt
    buffer_load_dwordx4 v[88:91], v1, s[36:39], s74 offen offset:2048 nt
    buffer_load_dwordx4 v[92:95], v1, s[36:39], s74 offen offset:2176 nt
    s_add_u32 s74, s73, 16384
    buffer_load_dwordx4 v[96:99], v1, s[36:39], s74 offen offset:0 nt
    buffer_load_dwordx4 v[100:103], v1, s[36:39], s74 offen offset:128 nt
    buffer_load_dwordx4 v[104:107], v1, s[36:39], s74 offen offset:2048 nt
    buffer_load_dwordx4 v[108:111], v1, s[36:39], s74 offen offset:2176 nt
    s_add_u32 s74, s73, 20480
    buffer_load_dwordx4 v[112:115], v1, s[36:39], s74 offen offset:0 nt
    buffer_load_dwordx4 v[116:119], v1, s[36:39], s74 offen offset:128 nt
    buffer_load_dwordx4 v[120:123], v1, s[36:39], s74 offen offset:2048 nt
    buffer_load_dwordx4 v[124:127], v1, s[36:39], s74 offen offset:2176 nt
    s_add_u32 s74, s73, 24576
    buffer_load_dwordx4 v[128:131], v1, s[36:39], s74 offen offset:0 nt
    buffer_load_dwordx4 v[132:135], v1, s[36:39], s74 offen offset:128 nt
    buffer_load_dwordx4 v[136:139], v1, s[36:39], s74 offen offset:2048 nt
    buffer_load_dwordx4 v[140:143], v1, s[36:39], s74 offen offset:2176 nt
    s_add_u32 s74, s73, 28672
    buffer_load_dwordx4 v[144:147], v1, s[36:39], s74 offen offset:0 nt
    buffer_load_dwordx4 v[148:151], v1, s[36:39], s74 offen offset:128 nt
    buffer_load_dwordx4 v[152:155], v1, s[36:39], s74 offen offset:2048 nt
    buffer_load_dwordx4 v[156:159], v1, s[36:39], s74 offen offset:2176 nt
    s_add_u32 s74, s73, 0
    buffer_load_dwordx4 v[160:163], v2, s[40:43], s74 offen offset:0 nt
    buffer_load_dwordx4 v[164:167], v2, s[40:43], s74 offen offset:1024 nt
    buffer_load_dwordx4 v[168:171], v2, s[40:43], s74 offen offset:2048 nt
    buffer_load_dwordx4 v[172:175], v2, s[40:43], s74 offen offset:3072 nt
    s_add_u32 s74, s73, 4096
    buffer_load_dwordx4 v[176:179], v2, s[40:43], s74 offen offset:0 nt
    buffer_load_dwordx4 v[180:183], v2, s[40:43], s74 offen offset:1024 nt
    buffer_load_dwordx4 v[184:187], v2, s[40:43], s74 offen offset:2048 nt
    buffer_load_dwordx4 v[188:191], v2, s[40:43], s74 offen offset:3072 nt
    s_add_u32 s74, s73, 8192
    buffer_load_dwordx4 v[192:195], v2, s[40:43], s74 offen offset:0 nt
    buffer_load_dwordx4 v[196:199], v2, s[40:43], s74 offen offset:1024 nt
    buffer_load_dwordx4 v[200:203], v2, s[40:43], s74 offen offset:2048 nt
    buffer_load_dwordx4 v[204:207], v2, s[40:43], s74 offen offset:3072 nt
    s_add_u32 s74, s73, 12288
    buffer_load_dwordx4 v[208:211], v2, s[40:43], s74 offen offset:0 nt
    buffer_load_dwordx4 v[212:215], v2, s[40:43], s74 offen offset:1024 nt
    buffer_load_dwordx4 v[216:219], v2, s[40:43], s74 offen offset:2048 nt
    buffer_load_dwordx4 v[220:223], v2, s[40:43], s74 offen offset:3072 nt
    s_waitcnt lgkmcnt(0)
    v_readfirstlane_b32 s91, v30
    s_nop 0
    s_add_u32 s91, s91, 1
    s_mul_i32 s56, s91, 0x9e3779b1
    s_lshr_b32 s57, s56, 8
    s_lshr_b32 s58, s56, 16
    s_lshr_b32 s59, s56, 24
    s_barrier
    s_branch L_QK
L_SVC:
    s_setprio 3
    v_lshrrev_b32 v28, 5, v0
    v_and_b32 v29, 31, v0
    v_lshlrev_b32 v27, 12, v28
    v_lshl_add_u32 v27, v29, 4, v27
    s_and_b32 s74, s2, 3
    s_lshl_b32 s86, s74, 15
    s_lshr_b32 s75, s2, 2
    s_and_b32 s75, s75, 1
    s_lshl_b32 s75, s75, 9
    s_add_u32 s86, s86, s75
    s_and_b32 s75, s72, 3
    s_lshl_b32 s95, s75, 13
    s_add_u32 s86, s86, s95
    buffer_load_dwordx4 v[160:163], v27, s[52:55], s86 offen offset:0 sc1
    buffer_load_dwordx4 v[164:167], v27, s[52:55], s86 offen offset:1024 sc1
    buffer_load_dwordx4 v[168:171], v27, s[52:55], s86 offen offset:2048 sc1
    buffer_load_dwordx4 v[172:175], v27, s[52:55], s86 offen offset:3072 sc1
    s_add_u32 s74, s73, 8192
    buffer_load_dwordx4 v[64:67], v1, s[36:39], s74 offen offset:0 nt
    buffer_load_dwordx4 v[68:71], v1, s[36:39], s74 offen offset:128 nt
    buffer_load_dwordx4 v[72:75], v1, s[36:39], s74 offen offset:2048 nt
    buffer_load_dwordx4 v[76:79], v1, s[36:39], s74 offen offset:2176 nt
    v_mul_u32_u24 v28, 272, v28
    v_lshrrev_b32 v26, 3, v29
    v_lshl_add_u32 v28, v26, 6, v28
    v_and_b32 v26, 7, v29
    v_lshl_add_u32 v28, v26, 1, v28
    s_mul_i32 s95, s75, 544
    v_add_u32 v28, s95, v28
    s_waitcnt lgkmcnt(0)
    v_readfirstlane_b32 s91, v30
    s_nop 0
    s_add_u32 s91, s91, 1
    s_mul_i32 s56, s91, 0x9e3779b1
    s_lshr_b32 s57, s56, 8
    s_lshr_b32 s58, s56, 16
    s_lshr_b32 s59, s56, 24
    s_mov_b32 s87, 0
    s_waitcnt vmcnt(4)
L_POLL0:
    v_perm_b32 v8, v161, v160, s92
    v_perm_b32 v9, v163, v162, s93
    v_or_b32 v10, v8, v9
    v_xor_b32 v10, s56, v10
    v_perm_b32 v8, v165, v164, s92
    v_perm_b32 v9, v167, v166, s93
    v_or_b32 v8, v8, v9
    v_xor_b32 v8, s56, v8
    v_or_b32 v10, v10, v8
    v_perm_b32 v8, v169, v168, s92
    v_perm_b32 v9, v171, v170, s93
    v_or_b32 v8, v8, v9
    v_xor_b32 v8, s56, v8
    v_or_b32 v10, v10, v8
    v_perm_b32 v8, v173, v172, s92
    v_perm_b32 v9, v175, v174, s93
    v_or_b32 v8, v8, v9
    v_xor_b32 v8, s56, v8
    v_or_b32 v10, v10, v8
    v_cmp_ne_u32 vcc, 0, v10
    s_nop 3
    s_cbranch_vccz L_POLL0_DONE
    s_add_u32 s87, s87, 1
    s_cmp_gt_u32 s87, 0x20000
    s_cbranch_scc1 L_POLL0_DONE
    s_mov_b64 exec, vcc
    buffer_load_dwordx4 v[160:163], v27, s[52:55], s86 offen offset:0 sc1
    buffer_load_dwordx4 v[164:167], v27, s[52:55], s86 offen offset:1024 sc1
    buffer_load_dwordx4 v[168:171], v27, s[52:55], s86 offen offset:2048 sc1
    buffer_load_dwordx4 v[172:175], v27, s[52:55], s86 offen offset:3072 sc1
    s_mov_b64 exec, -1
    s_waitcnt vmcnt(0)
    s_nop 2
    s_branch L_POLL0
L_POLL0_DONE:
    v_pk_add_f32 v[160:161], v[160:161], v[164:165]
    v_pk_add_f32 v[162:163], v[162:163], v[166:167]
    v_pk_add_f32 v[168:169], v[168:169], v[172:173]
    v_pk_add_f32 v[170:171], v[170:171], v[174:175]
    v_pk_add_f32 v[160:161], v[160:161], v[168:169]
    v_pk_add_f32 v[162:163], v[162:163], v[170:171]
    v_cvt_pk_bf16_f32 v160, v160, v161
    v_cvt_pk_bf16_f32 v161, v162, v163
    ds_write_b16 v28, v160 offset:8192
    ds_write_b16_d16_hi v28, v160 offset:8208
    ds_write_b16 v28, v161 offset:8224
    ds_write_b16_d16_hi v28, v161 offset:8240
    s_waitcnt lgkmcnt(0)
    s_barrier
    s_add_u32 s74, s73, 12288
    buffer_load_dwordx4 v[80:83], v1, s[36:39], s74 offen offset:0 nt
    buffer_load_dwordx4 v[84:87], v1, s[36:39], s74 offen offset:128 nt
    buffer_load_dwordx4 v[88:91], v1, s[36:39], s74 offen offset:2048 nt
    buffer_load_dwordx4 v[92:95], v1, s[36:39], s74 offen offset:2176 nt
    s_add_u32 s74, s73, 16384
    buffer_load_dwordx4 v[96:99], v1, s[36:39], s74 offen offset:0 nt
    buffer_load_dwordx4 v[100:103], v1, s[36:39], s74 offen offset:128 nt
    buffer_load_dwordx4 v[104:107], v1, s[36:39], s74 offen offset:2048 nt
    buffer_load_dwordx4 v[108:111], v1, s[36:39], s74 offen offset:2176 nt
    s_add_u32 s74, s73, 20480
    buffer_load_dwordx4 v[112:115], v1, s[36:39], s74 offen offset:0 nt
    buffer_load_dwordx4 v[116:119], v1, s[36:39], s74 offen offset:128 nt
    buffer_load_dwordx4 v[120:123], v1, s[36:39], s74 offen offset:2048 nt
    buffer_load_dwordx4 v[124:127], v1, s[36:39], s74 offen offset:2176 nt
    s_add_u32 s74, s73, 24576
    buffer_load_dwordx4 v[128:131], v1, s[36:39], s74 offen offset:0 nt
    buffer_load_dwordx4 v[132:135], v1, s[36:39], s74 offen offset:128 nt
    buffer_load_dwordx4 v[136:139], v1, s[36:39], s74 offen offset:2048 nt
    buffer_load_dwordx4 v[140:143], v1, s[36:39], s74 offen offset:2176 nt
    s_add_u32 s74, s73, 28672
    buffer_load_dwordx4 v[144:147], v1, s[36:39], s74 offen offset:0 nt
    buffer_load_dwordx4 v[148:151], v1, s[36:39], s74 offen offset:128 nt
    buffer_load_dwordx4 v[152:155], v1, s[36:39], s74 offen offset:2048 nt
    buffer_load_dwordx4 v[156:159], v1, s[36:39], s74 offen offset:2176 nt
    s_add_u32 s74, s73, 0
    buffer_load_dwordx4 v[160:163], v2, s[40:43], s74 offen offset:0 nt
    buffer_load_dwordx4 v[164:167], v2, s[40:43], s74 offen offset:1024 nt
    buffer_load_dwordx4 v[168:171], v2, s[40:43], s74 offen offset:2048 nt
    buffer_load_dwordx4 v[172:175], v2, s[40:43], s74 offen offset:3072 nt
    s_add_u32 s74, s73, 4096
    buffer_load_dwordx4 v[176:179], v2, s[40:43], s74 offen offset:0 nt
    buffer_load_dwordx4 v[180:183], v2, s[40:43], s74 offen offset:1024 nt
    buffer_load_dwordx4 v[184:187], v2, s[40:43], s74 offen offset:2048 nt
    buffer_load_dwordx4 v[188:191], v2, s[40:43], s74 offen offset:3072 nt
    s_add_u32 s74, s73, 8192
    buffer_load_dwordx4 v[192:195], v2, s[40:43], s74 offen offset:0 nt
    buffer_load_dwordx4 v[196:199], v2, s[40:43], s74 offen offset:1024 nt
    buffer_load_dwordx4 v[200:203], v2, s[40:43], s74 offen offset:2048 nt
    buffer_load_dwordx4 v[204:207], v2, s[40:43], s74 offen offset:3072 nt
    s_add_u32 s74, s73, 12288
    buffer_load_dwordx4 v[208:211], v2, s[40:43], s74 offen offset:0 nt
    buffer_load_dwordx4 v[212:215], v2, s[40:43], s74 offen offset:1024 nt
    buffer_load_dwordx4 v[216:219], v2, s[40:43], s74 offen offset:2048 nt
    buffer_load_dwordx4 v[220:223], v2, s[40:43], s74 offen offset:3072 nt
L_QK:
    v_and_b32 v28, 7, v0
    v_mul_u32_u24 v28, 272, v28
    v_lshl_add_u32 v28, v6, 4, v28
    v_lshrrev_b32 v29, 3, v5
    v_lshl_add_u32 v28, v29, 6, v28
    ds_read_b128 v[8:11], v28 offset:8192
    ds_read_b128 v[12:15], v28 offset:8320
    s_waitcnt lgkmcnt(0)
    s_waitcnt vmcnt(40)
    v_mfma_f32_16x16x32_bf16 v[16:19], v[32:35], v[8:11], 0
    v_mfma_f32_16x16x32_bf16 v[224:227], v[40:43], v[8:11], 0
    v_mfma_f32_16x16x32_bf16 v[20:23], v[48:51], v[8:11], 0
    v_mfma_f32_16x16x32_bf16 v[228:231], v[56:59], v[8:11], 0
    v_mfma_f32_16x16x32_bf16 v[16:19], v[36:39], v[12:15], v[16:19]
    v_mfma_f32_16x16x32_bf16 v[224:227], v[44:47], v[12:15], v[224:227]
    v_mfma_f32_16x16x32_bf16 v[20:23], v[52:55], v[12:15], v[20:23]
    v_mfma_f32_16x16x32_bf16 v[228:231], v[60:63], v[12:15], v[228:231]
    s_waitcnt vmcnt(32)
    v_mfma_f32_16x16x32_bf16 v[32:35], v[64:67], v[8:11], 0
    v_mfma_f32_16x16x32_bf16 v[232:235], v[72:75], v[8:11], 0
    v_mfma_f32_16x16x32_bf16 v[36:39], v[80:83], v[8:11], 0
    v_mfma_f32_16x16x32_bf16 v[236:239], v[88:91], v[8:11], 0
    v_mfma_f32_16x16x32_bf16 v[32:35], v[68:71], v[12:15], v[32:35]
    v_mfma_f32_16x16x32_bf16 v[232:235], v[76:79], v[12:15], v[232:235]
    v_mfma_f32_16x16x32_bf16 v[36:39], v[84:87], v[12:15], v[36:39]
    v_mfma_f32_16x16x32_bf16 v[236:239], v[92:95], v[12:15], v[236:239]
    v_permlane32_swap_b32 v224, v226
    v_permlane32_swap_b32 v225, v227
    v_permlane32_swap_b32 v16, v18
    v_permlane32_swap_b32 v17, v19
    v_permlane32_swap_b32 v228, v230
    v_permlane32_swap_b32 v229, v231
    v_permlane32_swap_b32 v20, v22
    v_permlane32_swap_b32 v21, v23
    v_add_f32_dpp v226, v226, v224 row_ror:8 row_mask:0xf bank_mask:0x3
    v_add_f32_dpp v227, v227, v225 row_ror:8 row_mask:0xf bank_mask:0x3
    v_add_f32_dpp v230, v230, v228 row_ror:8 row_mask:0xf bank_mask:0x3
    v_add_f32_dpp v231, v231, v229 row_ror:8 row_mask:0xf bank_mask:0x3
    v_add_f32_dpp v226, v224, v226 row_ror:8 row_mask:0xf bank_mask:0xc
    v_add_f32_dpp v227, v225, v227 row_ror:8 row_mask:0xf bank_mask:0xc
    v_add_f32_dpp v230, v228, v230 row_ror:8 row_mask:0xf bank_mask:0xc
    v_add_f32_dpp v231, v229, v231 row_ror:8 row_mask:0xf bank_mask:0xc
    v_add_f32_dpp v224, v18, v16 row_ror:8 row_mask:0xf bank_mask:0x3
    v_add_f32_dpp v225, v19, v17 row_ror:8 row_mask:0xf bank_mask:0x3
    v_add_f32_dpp v228, v22, v20 row_ror:8 row_mask:0xf bank_mask:0x3
    v_add_f32_dpp v229, v23, v21 row_ror:8 row_mask:0xf bank_mask:0x3
    v_add_f32_dpp v224, v16, v18 row_ror:8 row_mask:0xf bank_mask:0xc
    v_add_f32_dpp v225, v17, v19 row_ror:8 row_mask:0xf bank_mask:0xc
    v_add_f32_dpp v228, v20, v22 row_ror:8 row_mask:0xf bank_mask:0xc
    v_add_f32_dpp v229, v21, v23 row_ror:8 row_mask:0xf bank_mask:0xc
    s_waitcnt vmcnt(24)
    v_mfma_f32_16x16x32_bf16 v[64:67], v[96:99], v[8:11], 0
    v_mfma_f32_16x16x32_bf16 v[240:243], v[104:107], v[8:11], 0
    v_mfma_f32_16x16x32_bf16 v[68:71], v[112:115], v[8:11], 0
    v_mfma_f32_16x16x32_bf16 v[244:247], v[120:123], v[8:11], 0
    v_mfma_f32_16x16x32_bf16 v[64:67], v[100:103], v[12:15], v[64:67]
    v_mfma_f32_16x16x32_bf16 v[240:243], v[108:111], v[12:15], v[240:243]
    v_mfma_f32_16x16x32_bf16 v[68:71], v[116:119], v[12:15], v[68:71]
    v_mfma_f32_16x16x32_bf16 v[244:247], v[124:127], v[12:15], v[244:247]
    v_permlane32_swap_b32 v232, v234
    v_permlane32_swap_b32 v233, v235
    v_permlane32_swap_b32 v32, v34
    v_permlane32_swap_b32 v33, v35
    v_permlane32_swap_b32 v236, v238
    v_permlane32_swap_b32 v237, v239
    v_permlane32_swap_b32 v36, v38
    v_permlane32_swap_b32 v37, v39
    v_add_f32_dpp v234, v234, v232 row_ror:8 row_mask:0xf bank_mask:0x3
    v_add_f32_dpp v235, v235, v233 row_ror:8 row_mask:0xf bank_mask:0x3
    v_add_f32_dpp v238, v238, v236 row_ror:8 row_mask:0xf bank_mask:0x3
    v_add_f32_dpp v239, v239, v237 row_ror:8 row_mask:0xf bank_mask:0x3
    v_add_f32_dpp v234, v232, v234 row_ror:8 row_mask:0xf bank_mask:0xc
    v_add_f32_dpp v235, v233, v235 row_ror:8 row_mask:0xf bank_mask:0xc
    v_add_f32_dpp v238, v236, v238 row_ror:8 row_mask:0xf bank_mask:0xc
    v_add_f32_dpp v239, v237, v239 row_ror:8 row_mask:0xf bank_mask:0xc
    v_add_f32_dpp v232, v34, v32 row_ror:8 row_mask:0xf bank_mask:0x3
    v_add_f32_dpp v233, v35, v33 row_ror:8 row_mask:0xf bank_mask:0x3
    v_add_f32_dpp v236, v38, v36 row_ror:8 row_mask:0xf bank_mask:0x3
    v_add_f32_dpp v237, v39, v37 row_ror:8 row_mask:0xf bank_mask:0x3
    v_add_f32_dpp v232, v32, v34 row_ror:8 row_mask:0xf bank_mask:0xc
    v_add_f32_dpp v233, v33, v35 row_ror:8 row_mask:0xf bank_mask:0xc
    v_add_f32_dpp v236, v36, v38 row_ror:8 row_mask:0xf bank_mask:0xc
    v_add_f32_dpp v237, v37, v39 row_ror:8 row_mask:0xf bank_mask:0xc
    s_waitcnt vmcnt(16)
    v_mfma_f32_16x16x32_bf16 v[96:99], v[128:131], v[8:11], 0
    v_mfma_f32_16x16x32_bf16 v[248:251], v[136:139], v[8:11], 0
    v_mfma_f32_16x16x32_bf16 v[100:103], v[144:147], v[8:11], 0
    v_mfma_f32_16x16x32_bf16 v[252:255], v[152:155], v[8:11], 0
    v_mfma_f32_16x16x32_bf16 v[96:99], v[132:135], v[12:15], v[96:99]
    v_mfma_f32_16x16x32_bf16 v[248:251], v[140:143], v[12:15], v[248:251]
    v_mfma_f32_16x16x32_bf16 v[100:103], v[148:151], v[12:15], v[100:103]
    v_mfma_f32_16x16x32_bf16 v[252:255], v[156:159], v[12:15], v[252:255]
    v_permlane32_swap_b32 v240, v242
    v_permlane32_swap_b32 v241, v243
    v_permlane32_swap_b32 v64, v66
    v_permlane32_swap_b32 v65, v67
    v_permlane32_swap_b32 v244, v246
    v_permlane32_swap_b32 v245, v247
    v_permlane32_swap_b32 v68, v70
    v_permlane32_swap_b32 v69, v71
    v_add_f32_dpp v242, v242, v240 row_ror:8 row_mask:0xf bank_mask:0x3
    v_add_f32_dpp v243, v243, v241 row_ror:8 row_mask:0xf bank_mask:0x3
    v_add_f32_dpp v246, v246, v244 row_ror:8 row_mask:0xf bank_mask:0x3
    v_add_f32_dpp v247, v247, v245 row_ror:8 row_mask:0xf bank_mask:0x3
    v_add_f32_dpp v242, v240, v242 row_ror:8 row_mask:0xf bank_mask:0xc
    v_add_f32_dpp v243, v241, v243 row_ror:8 row_mask:0xf bank_mask:0xc
    v_add_f32_dpp v246, v244, v246 row_ror:8 row_mask:0xf bank_mask:0xc
    v_add_f32_dpp v247, v245, v247 row_ror:8 row_mask:0xf bank_mask:0xc
    v_add_f32_dpp v240, v66, v64 row_ror:8 row_mask:0xf bank_mask:0x3
    v_add_f32_dpp v241, v67, v65 row_ror:8 row_mask:0xf bank_mask:0x3
    v_add_f32_dpp v244, v70, v68 row_ror:8 row_mask:0xf bank_mask:0x3
    v_add_f32_dpp v245, v71, v69 row_ror:8 row_mask:0xf bank_mask:0x3
    v_add_f32_dpp v240, v64, v66 row_ror:8 row_mask:0xf bank_mask:0xc
    v_add_f32_dpp v241, v65, v67 row_ror:8 row_mask:0xf bank_mask:0xc
    v_add_f32_dpp v244, v68, v70 row_ror:8 row_mask:0xf bank_mask:0xc
    v_add_f32_dpp v245, v69, v71 row_ror:8 row_mask:0xf bank_mask:0xc
    v_permlane32_swap_b32 v248, v250
    v_permlane32_swap_b32 v249, v251
    v_permlane32_swap_b32 v96, v98
    v_permlane32_swap_b32 v97, v99
    v_permlane32_swap_b32 v252, v254
    v_permlane32_swap_b32 v253, v255
    v_permlane32_swap_b32 v100, v102
    v_permlane32_swap_b32 v101, v103
    v_add_f32_dpp v250, v250, v248 row_ror:8 row_mask:0xf bank_mask:0x3
    v_add_f32_dpp v251, v251, v249 row_ror:8 row_mask:0xf bank_mask:0x3
    v_add_f32_dpp v254, v254, v252 row_ror:8 row_mask:0xf bank_mask:0x3
    v_add_f32_dpp v255, v255, v253 row_ror:8 row_mask:0xf bank_mask:0x3
    v_add_f32_dpp v250, v248, v250 row_ror:8 row_mask:0xf bank_mask:0xc
    v_add_f32_dpp v251, v249, v251 row_ror:8 row_mask:0xf bank_mask:0xc
    v_add_f32_dpp v254, v252, v254 row_ror:8 row_mask:0xf bank_mask:0xc
    v_add_f32_dpp v255, v253, v255 row_ror:8 row_mask:0xf bank_mask:0xc
    v_add_f32_dpp v248, v98, v96 row_ror:8 row_mask:0xf bank_mask:0x3
    v_add_f32_dpp v249, v99, v97 row_ror:8 row_mask:0xf bank_mask:0x3
    v_add_f32_dpp v252, v102, v100 row_ror:8 row_mask:0xf bank_mask:0x3
    v_add_f32_dpp v253, v103, v101 row_ror:8 row_mask:0xf bank_mask:0x3
    v_add_f32_dpp v248, v96, v98 row_ror:8 row_mask:0xf bank_mask:0xc
    v_add_f32_dpp v249, v97, v99 row_ror:8 row_mask:0xf bank_mask:0xc
    v_add_f32_dpp v252, v100, v102 row_ror:8 row_mask:0xf bank_mask:0xc
    v_add_f32_dpp v253, v101, v103 row_ror:8 row_mask:0xf bank_mask:0xc
    v_cvt_pk_bf16_f32 v8, v224, v225
    v_cvt_pk_bf16_f32 v9, v226, v227
    v_cvt_pk_bf16_f32 v10, v228, v229
    v_cvt_pk_bf16_f32 v11, v230, v231
    v_cvt_pk_bf16_f32 v12, v232, v233
    v_cvt_pk_bf16_f32 v13, v234, v235
    v_cvt_pk_bf16_f32 v14, v236, v237
    v_cvt_pk_bf16_f32 v15, v238, v239
    v_cvt_pk_bf16_f32 v16, v240, v241
    v_cvt_pk_bf16_f32 v17, v242, v243
    v_cvt_pk_bf16_f32 v18, v244, v245
    v_cvt_pk_bf16_f32 v19, v246, v247
    v_cvt_pk_bf16_f32 v20, v248, v249
    v_cvt_pk_bf16_f32 v21, v250, v251
    v_cvt_pk_bf16_f32 v22, v252, v253
    v_cvt_pk_bf16_f32 v23, v254, v255
    v_lshlrev_b32 v224, 16, v8
    v_and_b32 v225, s90, v8
    v_lshlrev_b32 v226, 16, v9
    v_and_b32 v227, s90, v9
    v_lshlrev_b32 v228, 16, v10
    v_and_b32 v229, s90, v10
    v_lshlrev_b32 v230, 16, v11
    v_and_b32 v231, s90, v11
    v_lshlrev_b32 v232, 16, v12
    v_and_b32 v233, s90, v12
    v_lshlrev_b32 v234, 16, v13
    v_and_b32 v235, s90, v13
    v_lshlrev_b32 v236, 16, v14
    v_and_b32 v237, s90, v14
    v_lshlrev_b32 v238, 16, v15
    v_and_b32 v239, s90, v15
    v_lshlrev_b32 v240, 16, v16
    v_and_b32 v241, s90, v16
    v_lshlrev_b32 v242, 16, v17
    v_and_b32 v243, s90, v17
    v_lshlrev_b32 v244, 16, v18
    v_and_b32 v245, s90, v18
    v_lshlrev_b32 v246, 16, v19
    v_and_b32 v247, s90, v19
    v_lshlrev_b32 v248, 16, v20
    v_and_b32 v249, s90, v20
    v_lshlrev_b32 v250, 16, v21
    v_and_b32 v251, s90, v21
    v_lshlrev_b32 v252, 16, v22
    v_and_b32 v253, s90, v22
    v_lshlrev_b32 v254, 16, v23
    v_and_b32 v255, s90, v23
    v_pk_mul_f32 v[224:225], v[224:225], s[88:89] op_sel_hi:[1,0]
    v_pk_mul_f32 v[226:227], v[226:227], s[88:89] op_sel_hi:[1,0]
    v_pk_mul_f32 v[228:229], v[228:229], s[88:89] op_sel_hi:[1,0]
    v_pk_mul_f32 v[230:231], v[230:231], s[88:89] op_sel_hi:[1,0]
    v_pk_mul_f32 v[232:233], v[232:233], s[88:89] op_sel_hi:[1,0]
    v_pk_mul_f32 v[234:235], v[234:235], s[88:89] op_sel_hi:[1,0]
    v_pk_mul_f32 v[236:237], v[236:237], s[88:89] op_sel_hi:[1,0]
    v_pk_mul_f32 v[238:239], v[238:239], s[88:89] op_sel_hi:[1,0]
    v_pk_mul_f32 v[240:241], v[240:241], s[88:89] op_sel_hi:[1,0]
    v_pk_mul_f32 v[242:243], v[242:243], s[88:89] op_sel_hi:[1,0]
    v_pk_mul_f32 v[244:245], v[244:245], s[88:89] op_sel_hi:[1,0]
    v_pk_mul_f32 v[246:247], v[246:247], s[88:89] op_sel_hi:[1,0]
    v_pk_mul_f32 v[248:249], v[248:249], s[88:89] op_sel_hi:[1,0]
    v_pk_mul_f32 v[250:251], v[250:251], s[88:89] op_sel_hi:[1,0]
    v_pk_mul_f32 v[252:253], v[252:253], s[88:89] op_sel_hi:[1,0]
    v_pk_mul_f32 v[254:255], v[254:255], s[88:89] op_sel_hi:[1,0]
    v_cvt_pk_bf16_f32 v8, v224, v225
    v_cvt_pk_bf16_f32 v9, v226, v227
    v_cvt_pk_bf16_f32 v10, v228, v229
    v_cvt_pk_bf16_f32 v11, v230, v231
    v_cvt_pk_bf16_f32 v12, v232, v233
    v_cvt_pk_bf16_f32 v13, v234, v235
    v_cvt_pk_bf16_f32 v14, v236, v237
    v_cvt_pk_bf16_f32 v15, v238, v239
    v_cvt_pk_bf16_f32 v16, v240, v241
    v_cvt_pk_bf16_f32 v17, v242, v243
    v_cvt_pk_bf16_f32 v18, v244, v245
    v_cvt_pk_bf16_f32 v19, v246, v247
    v_cvt_pk_bf16_f32 v20, v248, v249
    v_cvt_pk_bf16_f32 v21, v250, v251
    v_cvt_pk_bf16_f32 v22, v252, v253
    v_cvt_pk_bf16_f32 v23, v254, v255
    v_lshlrev_b32 v224, 16, v8
    v_and_b32 v225, s90, v8
    v_lshlrev_b32 v226, 16, v9
    v_and_b32 v227, s90, v9
    v_lshlrev_b32 v228, 16, v10
    v_and_b32 v229, s90, v10
    v_lshlrev_b32 v230, 16, v11
    v_and_b32 v231, s90, v11
    v_lshlrev_b32 v232, 16, v12
    v_and_b32 v233, s90, v12
    v_lshlrev_b32 v234, 16, v13
    v_and_b32 v235, s90, v13
    v_lshlrev_b32 v236, 16, v14
    v_and_b32 v237, s90, v14
    v_lshlrev_b32 v238, 16, v15
    v_and_b32 v239, s90, v15
    v_lshlrev_b32 v240, 16, v16
    v_and_b32 v241, s90, v16
    v_lshlrev_b32 v242, 16, v17
    v_and_b32 v243, s90, v17
    v_lshlrev_b32 v244, 16, v18
    v_and_b32 v245, s90, v18
    v_lshlrev_b32 v246, 16, v19
    v_and_b32 v247, s90, v19
    v_lshlrev_b32 v248, 16, v20
    v_and_b32 v249, s90, v20
    v_lshlrev_b32 v250, 16, v21
    v_and_b32 v251, s90, v21
    v_lshlrev_b32 v252, 16, v22
    v_and_b32 v253, s90, v22
    v_lshlrev_b32 v254, 16, v23
    v_and_b32 v255, s90, v23
    v_max3_f32 v8, v224, v228, v232
    v_max3_f32 v9, v225, v229, v233
    v_max3_f32 v10, v226, v230, v234
    v_max3_f32 v11, v227, v231, v235
    v_max3_f32 v8, v8, v236, v240
    v_max3_f32 v9, v9, v237, v241
    v_max3_f32 v10, v10, v238, v242
    v_max3_f32 v11, v11, v239, v243
    v_max3_f32 v8, v8, v244, v248
    v_max3_f32 v9, v9, v245, v249
    v_max3_f32 v10, v10, v246, v250
    v_max3_f32 v11, v11, v247, v251
    v_max_f32 v8, v8, v252
    v_max_f32 v9, v9, v253
    v_max_f32 v10, v10, v254
    v_max_f32 v11, v11, v255
    v_max3_f32 v8, v8, v9, v10
    v_max_f32 v8, v8, v11
    v_mov_b32 v9, v8
    s_nop 1
    v_permlane16_swap_b32 v8, v9
    v_max_f32 v8, v8, v9
    v_mov_b32 v9, v8
    s_nop 1
    v_permlane32_swap_b32 v8, v9
    v_max_f32 v8, v8, v9
    v_and_b32 v28, 7, v0
    v_lshlrev_b32 v28, 5, v28
    s_lshl_b32 s74, s72, 2
    v_add_u32 v29, s74, v28
    s_mov_b64 exec, 0xff
    ds_write_b32 v29, v8 offset:10368
    s_mov_b64 exec, -1
    s_waitcnt lgkmcnt(0)
    s_barrier
    ds_read_b128 v[8:11], v28 offset:10368
    ds_read_b128 v[12:15], v28 offset:10384
    s_waitcnt lgkmcnt(0)
    v_max3_f32 v8, v8, v9, v10
    v_max3_f32 v12, v12, v13, v14
    v_max3_f32 v8, v8, v11, v15
    v_max_f32 v8, v8, v12
    v_mul_f32 v7, s89, v8
    v_fma_f32 v224, v224, s89, -v7
    v_fma_f32 v225, v225, s89, -v7
    v_fma_f32 v226, v226, s89, -v7
    v_fma_f32 v227, v227, s89, -v7
    v_fma_f32 v228, v228, s89, -v7
    v_fma_f32 v229, v229, s89, -v7
    v_fma_f32 v230, v230, s89, -v7
    v_fma_f32 v231, v231, s89, -v7
    v_fma_f32 v232, v232, s89, -v7
    v_fma_f32 v233, v233, s89, -v7
    v_fma_f32 v234, v234, s89, -v7
    v_fma_f32 v235, v235, s89, -v7
    v_fma_f32 v236, v236, s89, -v7
    v_fma_f32 v237, v237, s89, -v7
    v_fma_f32 v238, v238, s89, -v7
    v_fma_f32 v239, v239, s89, -v7
    v_fma_f32 v240, v240, s89, -v7
    v_fma_f32 v241, v241, s89, -v7
    v_fma_f32 v242, v242, s89, -v7
    v_fma_f32 v243, v243, s89, -v7
    v_fma_f32 v244, v244, s89, -v7
    v_fma_f32 v245, v245, s89, -v7
    v_fma_f32 v246, v246, s89, -v7
    v_fma_f32 v247, v247, s89, -v7
    v_fma_f32 v248, v248, s89, -v7
    v_fma_f32 v249, v249, s89, -v7
    v_fma_f32 v250, v250, s89, -v7
    v_fma_f32 v251, v251, s89, -v7
    v_fma_f32 v252, v252, s89, -v7
    v_fma_f32 v253, v253, s89, -v7
    v_fma_f32 v254, v254, s89, -v7
    v_fma_f32 v255, v255, s89, -v7
    v_exp_f32 v224, v224
    v_exp_f32 v225, v225
    v_exp_f32 v226, v226
    v_exp_f32 v227, v227
    v_exp_f32 v228, v228
    v_exp_f32 v229, v229
    v_exp_f32 v230, v230
    v_exp_f32 v231, v231
    v_exp_f32 v232, v232
    v_exp_f32 v233, v233
    v_exp_f32 v234, v234
    v_exp_f32 v235, v235
    v_exp_f32 v236, v236
    v_exp_f32 v237, v237
    v_exp_f32 v238, v238
    v_exp_f32 v239, v239
    v_exp_f32 v240, v240
    v_exp_f32 v241, v241
    v_exp_f32 v242, v242
    v_exp_f32 v243, v243
    v_exp_f32 v244, v244
    v_exp_f32 v245, v245
    v_exp_f32 v246, v246
    v_exp_f32 v247, v247
    v_exp_f32 v248, v248
    v_exp_f32 v249, v249
    v_exp_f32 v250, v250
    v_exp_f32 v251, v251
    v_exp_f32 v252, v252
    v_exp_f32 v253, v253
    v_exp_f32 v254, v254
    v_exp_f32 v255, v255
    v_add_f32 v8, v224, v228
    v_add_f32 v9, v225, v229
    v_add_f32 v10, v226, v230
    v_add_f32 v11, v227, v231
    v_add_f32 v8, v8, v232
    v_add_f32 v9, v9, v233
    v_add_f32 v10, v10, v234
    v_add_f32 v11, v11, v235
    v_add_f32 v8, v8, v236
    v_add_f32 v9, v9, v237
    v_add_f32 v10, v10, v238
    v_add_f32 v11, v11, v239
    v_add_f32 v8, v8, v240
    v_add_f32 v9, v9, v241
    v_add_f32 v10, v10, v242
    v_add_f32 v11, v11, v243
    v_add_f32 v8, v8, v244
    v_add_f32 v9, v9, v245
    v_add_f32 v10, v10, v246
    v_add_f32 v11, v11, v247
    v_add_f32 v8, v8, v248
    v_add_f32 v9, v9, v249
    v_add_f32 v10, v10, v250
    v_add_f32 v11, v11, v251
    v_add_f32 v8, v8, v252
    v_add_f32 v9, v9, v253
    v_add_f32 v10, v10, v254
    v_add_f32 v11, v11, v255
    v_add_f32 v8, v8, v9
    v_add_f32 v10, v10, v11
    v_add_f32 v8, v8, v10
    v_mov_b32 v9, v8
    s_nop 1
    v_permlane16_swap_b32 v8, v9
    v_add_f32 v8, v8, v9
    v_mov_b32 v9, v8
    s_nop 1
    v_permlane32_swap_b32 v8, v9
    v_add_f32 v8, v8, v9
    s_mov_b64 exec, 0xff
    ds_write_b32 v29, v8 offset:10624
    s_mov_b64 exec, -1
    s_waitcnt lgkmcnt(0)
    s_barrier
    s_cmp_lt_u32 s72, 4
    s_nop 0
    s_cbranch_scc1 L_AV
    s_cmp_lg_u32 s72, 4
    s_cbranch_scc1 L_BX
    ds_read_b128 v[8:11], v28 offset:10624
    ds_read_b128 v[12:15], v28 offset:10640
    v_lshlrev_b32 v28, 4, v28
    v_mov_b32 v16, v7
    v_mov_b32 v18, s56
    v_mov_b32 v19, s56
    s_waitcnt lgkmcnt(0)
    v_pk_add_f32 v[8:9], v[8:9], v[10:11]
    v_pk_add_f32 v[12:13], v[12:13], v[14:15]
    v_pk_add_f32 v[8:9], v[8:9], v[12:13]
    v_add_f32 v17, v8, v9
    s_mov_b64 exec, 0xff
    buffer_store_dwordx4 v[16:19], v28, s[52:55], s85 offen sc1
    s_mov_b64 exec, -1
L_BX:
    v_bfe_u32 v26, v0, 3, 1
    v_lshlrev_b32 v26, 5, v26
    v_and_b32 v27, 16, v0
    v_or_b32 v26, v26, v27
    v_and_b32 v27, 1, v0
    v_lshl_add_u32 v158, v27, 1, v26
    s_and_b32 s74, s2, 7
    s_lshl_b32 s74, s74, 8
    s_lshr_b32 s95, s94, 2
    s_and_b32 s95, s95, 3
    s_lshl_b32 s95, s95, 6
    s_add_u32 s74, s74, s95
    s_and_b32 s95, s94, 3
    s_lshl_b32 s95, s95, 2
    s_add_u32 s74, s74, s95
    s_lshr_b32 s95, s94, 4
    s_lshl_b32 s95, s95, 11
    s_add_u32 s86, s74, s95
    buffer_load_ushort v157, v158, s[68:71], s74 offen
    buffer_load_ushort v156, v158, s[32:35], s86 offen
    s_add_u32 s74, s73, 16384
    buffer_load_dwordx4 v[32:35], v2, s[40:43], s74 offen offset:0 nt
    buffer_load_dwordx4 v[36:39], v2, s[40:43], s74 offen offset:1024 nt
    buffer_load_dwordx4 v[40:43], v2, s[40:43], s74 offen offset:2048 nt
    buffer_load_dwordx4 v[44:47], v2, s[40:43], s74 offen offset:3072 nt
    s_add_u32 s74, s73, 20480
    buffer_load_dwordx4 v[48:51], v2, s[40:43], s74 offen offset:0 nt
    buffer_load_dwordx4 v[52:55], v2, s[40:43], s74 offen offset:1024 nt
    buffer_load_dwordx4 v[56:59], v2, s[40:43], s74 offen offset:2048 nt
    buffer_load_dwordx4 v[60:63], v2, s[40:43], s74 offen offset:3072 nt
    s_add_u32 s74, s73, 24576
    buffer_load_dwordx4 v[64:67], v2, s[40:43], s74 offen offset:0 nt
    buffer_load_dwordx4 v[68:71], v2, s[40:43], s74 offen offset:1024 nt
    buffer_load_dwordx4 v[72:75], v2, s[40:43], s74 offen offset:2048 nt
    buffer_load_dwordx4 v[76:79], v2, s[40:43], s74 offen offset:3072 nt
    s_add_u32 s74, s73, 28672
    buffer_load_dwordx4 v[80:83], v2, s[40:43], s74 offen offset:0 nt
    buffer_load_dwordx4 v[84:87], v2, s[40:43], s74 offen offset:1024 nt
    buffer_load_dwordx4 v[88:91], v2, s[40:43], s74 offen offset:2048 nt
    buffer_load_dwordx4 v[92:95], v2, s[40:43], s74 offen offset:3072 nt
    s_setprio 1
    s_branch L_PV
L_AV:
    s_setprio 2
    s_add_u32 s74, s73, 16384
    buffer_load_dwordx4 v[32:35], v2, s[40:43], s74 offen offset:0 nt
    buffer_load_dwordx4 v[36:39], v2, s[40:43], s74 offen offset:1024 nt
    buffer_load_dwordx4 v[40:43], v2, s[40:43], s74 offen offset:2048 nt
    buffer_load_dwordx4 v[44:47], v2, s[40:43], s74 offen offset:3072 nt
    s_add_u32 s74, s73, 20480
    buffer_load_dwordx4 v[48:51], v2, s[40:43], s74 offen offset:0 nt
    buffer_load_dwordx4 v[52:55], v2, s[40:43], s74 offen offset:1024 nt
    buffer_load_dwordx4 v[56:59], v2, s[40:43], s74 offen offset:2048 nt
    buffer_load_dwordx4 v[60:63], v2, s[40:43], s74 offen offset:3072 nt
    s_add_u32 s74, s73, 24576
    buffer_load_dwordx4 v[64:67], v2, s[40:43], s74 offen offset:0 nt
    buffer_load_dwordx4 v[68:71], v2, s[40:43], s74 offen offset:1024 nt
    buffer_load_dwordx4 v[72:75], v2, s[40:43], s74 offen offset:2048 nt
    buffer_load_dwordx4 v[76:79], v2, s[40:43], s74 offen offset:3072 nt
    s_add_u32 s74, s73, 28672
    buffer_load_dwordx4 v[80:83], v2, s[40:43], s74 offen offset:0 nt
    buffer_load_dwordx4 v[84:87], v2, s[40:43], s74 offen offset:1024 nt
    buffer_load_dwordx4 v[88:91], v2, s[40:43], s74 offen offset:2048 nt
    buffer_load_dwordx4 v[92:95], v2, s[40:43], s74 offen offset:3072 nt
    s_setprio 0
    v_lshrrev_b32 v30, 5, v0
    v_lshlrev_b32 v30, 14, v30
    v_and_b32 v27, 31, v0
    v_lshl_add_u32 v30, v27, 4, v30
    v_lshrrev_b32 v26, 3, v0
    v_lshlrev_b32 v26, 9, v26
    v_and_b32 v27, 7, v0
    v_lshl_add_u32 v26, v27, 4, v26
L_PV:
    v_cvt_pk_bf16_f32 v224, v224, v225
    v_cvt_pk_bf16_f32 v225, v226, v227
    v_cvt_pk_bf16_f32 v226, v228, v229
    v_cvt_pk_bf16_f32 v227, v230, v231
    v_cndmask_b32 v228, v224, 0, s[82:83]
    v_cndmask_b32 v229, v225, 0, s[82:83]
    v_cndmask_b32 v230, v226, 0, s[82:83]
    v_cndmask_b32 v231, v227, 0, s[82:83]
    v_cndmask_b32 v224, 0, v224, s[82:83]
    v_cndmask_b32 v225, 0, v225, s[82:83]
    v_cndmask_b32 v226, 0, v226, s[82:83]
    v_cndmask_b32 v227, 0, v227, s[82:83]
    v_cvt_pk_bf16_f32 v232, v232, v233
    v_cvt_pk_bf16_f32 v233, v234, v235
    v_cvt_pk_bf16_f32 v234, v236, v237
    v_cvt_pk_bf16_f32 v235, v238, v239
    v_cndmask_b32 v236, v232, 0, s[82:83]
    v_cndmask_b32 v237, v233, 0, s[82:83]
    v_cndmask_b32 v238, v234, 0, s[82:83]
    v_cndmask_b32 v239, v235, 0, s[82:83]
    v_cndmask_b32 v232, 0, v232, s[82:83]
    v_cndmask_b32 v233, 0, v233, s[82:83]
    v_cndmask_b32 v234, 0, v234, s[82:83]
    v_cndmask_b32 v235, 0, v235, s[82:83]
    v_cvt_pk_bf16_f32 v240, v240, v241
    v_cvt_pk_bf16_f32 v241, v242, v243
    v_cvt_pk_bf16_f32 v242, v244, v245
    v_cvt_pk_bf16_f32 v243, v246, v247
    v_cndmask_b32 v244, v240, 0, s[82:83]
    v_cndmask_b32 v245, v241, 0, s[82:83]
    v_cndmask_b32 v246, v242, 0, s[82:83]
    v_cndmask_b32 v247, v243, 0, s[82:83]
    v_cndmask_b32 v240, 0, v240, s[82:83]
    v_cndmask_b32 v241, 0, v241, s[82:83]
    v_cndmask_b32 v242, 0, v242, s[82:83]
    v_cndmask_b32 v243, 0, v243, s[82:83]
    v_cvt_pk_bf16_f32 v248, v248, v249
    v_cvt_pk_bf16_f32 v249, v250, v251
    v_cvt_pk_bf16_f32 v250, v252, v253
    v_cvt_pk_bf16_f32 v251, v254, v255
    v_cndmask_b32 v252, v248, 0, s[82:83]
    v_cndmask_b32 v253, v249, 0, s[82:83]
    v_cndmask_b32 v254, v250, 0, s[82:83]
    v_cndmask_b32 v255, v251, 0, s[82:83]
    v_cndmask_b32 v248, 0, v248, s[82:83]
    v_cndmask_b32 v249, 0, v249, s[82:83]
    v_cndmask_b32 v250, 0, v250, s[82:83]
    v_cndmask_b32 v251, 0, v251, s[82:83]
    s_waitcnt vmcnt(24)
    v_perm_b32 v8, v164, v160, s77
    v_perm_b32 v9, v172, v168, s77
    v_perm_b32 v10, v180, v176, s77
    v_perm_b32 v11, v188, v184, s77
    v_perm_b32 v12, v165, v161, s77
    v_perm_b32 v13, v173, v169, s77
    v_perm_b32 v14, v181, v177, s77
    v_perm_b32 v15, v189, v185, s77
    v_mfma_f32_16x16x32_bf16 v[128:131], v[8:11], v[224:227], 0
    v_perm_b32 v16, v166, v162, s77
    v_perm_b32 v17, v174, v170, s77
    v_perm_b32 v18, v182, v178, s77
    v_perm_b32 v19, v190, v186, s77
    v_mfma_f32_16x16x32_bf16 v[132:135], v[12:15], v[224:227], 0
    v_perm_b32 v20, v167, v163, s77
    v_perm_b32 v21, v175, v171, s77
    v_perm_b32 v22, v183, v179, s77
    v_perm_b32 v23, v191, v187, s77
    v_mfma_f32_16x16x32_bf16 v[136:139], v[16:19], v[224:227], 0
    v_perm_b32 v8, v164, v160, s78
    v_perm_b32 v9, v172, v168, s78
    v_perm_b32 v10, v180, v176, s78
    v_perm_b32 v11, v188, v184, s78
    v_mfma_f32_16x16x32_bf16 v[140:143], v[20:23], v[224:227], 0
    v_perm_b32 v12, v165, v161, s78
    v_perm_b32 v13, v173, v169, s78
    v_perm_b32 v14, v181, v177, s78
    v_perm_b32 v15, v189, v185, s78
    v_mfma_f32_16x16x32_bf16 v[128:131], v[8:11], v[228:231], v[128:131]
    v_perm_b32 v16, v166, v162, s78
    v_perm_b32 v17, v174, v170, s78
    v_perm_b32 v18, v182, v178, s78
    v_perm_b32 v19, v190, v186, s78
    v_mfma_f32_16x16x32_bf16 v[132:135], v[12:15], v[228:231], v[132:135]
    v_perm_b32 v20, v167, v163, s78
    v_perm_b32 v21, v175, v171, s78
    v_perm_b32 v22, v183, v179, s78
    v_perm_b32 v23, v191, v187, s78
    v_mfma_f32_16x16x32_bf16 v[136:139], v[16:19], v[228:231], v[136:139]
    s_nop 0
    v_mfma_f32_16x16x32_bf16 v[140:143], v[20:23], v[228:231], v[140:143]
    s_waitcnt vmcnt(16)
    v_perm_b32 v8, v196, v192, s77
    v_perm_b32 v9, v204, v200, s77
    v_perm_b32 v10, v212, v208, s77
    v_perm_b32 v11, v220, v216, s77
    v_perm_b32 v12, v197, v193, s77
    v_perm_b32 v13, v205, v201, s77
    v_perm_b32 v14, v213, v209, s77
    v_perm_b32 v15, v221, v217, s77
    v_mfma_f32_16x16x32_bf16 v[128:131], v[8:11], v[232:235], v[128:131]
    v_perm_b32 v16, v198, v194, s77
    v_perm_b32 v17, v206, v202, s77
    v_perm_b32 v18, v214, v210, s77
    v_perm_b32 v19, v222, v218, s77
    v_mfma_f32_16x16x32_bf16 v[132:135], v[12:15], v[232:235], v[132:135]
    v_perm_b32 v20, v199, v195, s77
    v_perm_b32 v21, v207, v203, s77
    v_perm_b32 v22, v215, v211, s77
    v_perm_b32 v23, v223, v219, s77
    v_mfma_f32_16x16x32_bf16 v[136:139], v[16:19], v[232:235], v[136:139]
    v_perm_b32 v8, v196, v192, s78
    v_perm_b32 v9, v204, v200, s78
    v_perm_b32 v10, v212, v208, s78
    v_perm_b32 v11, v220, v216, s78
    v_mfma_f32_16x16x32_bf16 v[140:143], v[20:23], v[232:235], v[140:143]
    v_perm_b32 v12, v197, v193, s78
    v_perm_b32 v13, v205, v201, s78
    v_perm_b32 v14, v213, v209, s78
    v_perm_b32 v15, v221, v217, s78
    v_mfma_f32_16x16x32_bf16 v[128:131], v[8:11], v[236:239], v[128:131]
    v_perm_b32 v16, v198, v194, s78
    v_perm_b32 v17, v206, v202, s78
    v_perm_b32 v18, v214, v210, s78
    v_perm_b32 v19, v222, v218, s78
    v_mfma_f32_16x16x32_bf16 v[132:135], v[12:15], v[236:239], v[132:135]
    v_perm_b32 v20, v199, v195, s78
    v_perm_b32 v21, v207, v203, s78
    v_perm_b32 v22, v215, v211, s78
    v_perm_b32 v23, v223, v219, s78
    v_mfma_f32_16x16x32_bf16 v[136:139], v[16:19], v[236:239], v[136:139]
    s_nop 0
    v_mfma_f32_16x16x32_bf16 v[140:143], v[20:23], v[236:239], v[140:143]
    s_cmp_lg_u32 s72, 7
    s_nop 5
    s_cbranch_scc1 L_NOTK
    v_mov_b32 v159, 1
    s_mov_b64 exec, 1
    buffer_atomic_add v159, off, s[4:7], 0 sc0 sc1
    s_mov_b64 exec, -1
L_NOTK:
    s_waitcnt vmcnt(8)
    v_perm_b32 v8, v36, v32, s77
    v_perm_b32 v9, v44, v40, s77
    v_perm_b32 v10, v52, v48, s77
    v_perm_b32 v11, v60, v56, s77
    v_perm_b32 v12, v37, v33, s77
    v_perm_b32 v13, v45, v41, s77
    v_perm_b32 v14, v53, v49, s77
    v_perm_b32 v15, v61, v57, s77
    v_mfma_f32_16x16x32_bf16 v[128:131], v[8:11], v[240:243], v[128:131]
    v_perm_b32 v16, v38, v34, s77
    v_perm_b32 v17, v46, v42, s77
    v_perm_b32 v18, v54, v50, s77
    v_perm_b32 v19, v62, v58, s77
    v_mfma_f32_16x16x32_bf16 v[132:135], v[12:15], v[240:243], v[132:135]
    v_perm_b32 v20, v39, v35, s77
    v_perm_b32 v21, v47, v43, s77
    v_perm_b32 v22, v55, v51, s77
    v_perm_b32 v23, v63, v59, s77
    v_mfma_f32_16x16x32_bf16 v[136:139], v[16:19], v[240:243], v[136:139]
    v_perm_b32 v8, v36, v32, s78
    v_perm_b32 v9, v44, v40, s78
    v_perm_b32 v10, v52, v48, s78
    v_perm_b32 v11, v60, v56, s78
    v_mfma_f32_16x16x32_bf16 v[140:143], v[20:23], v[240:243], v[140:143]
    v_perm_b32 v12, v37, v33, s78
    v_perm_b32 v13, v45, v41, s78
    v_perm_b32 v14, v53, v49, s78
    v_perm_b32 v15, v61, v57, s78
    v_mfma_f32_16x16x32_bf16 v[128:131], v[8:11], v[244:247], v[128:131]
    v_perm_b32 v16, v38, v34, s78
    v_perm_b32 v17, v46, v42, s78
    v_perm_b32 v18, v54, v50, s78
    v_perm_b32 v19, v62, v58, s78
    v_mfma_f32_16x16x32_bf16 v[132:135], v[12:15], v[244:247], v[132:135]
    v_perm_b32 v20, v39, v35, s78
    v_perm_b32 v21, v47, v43, s78
    v_perm_b32 v22, v55, v51, s78
    v_perm_b32 v23, v63, v59, s78
    v_mfma_f32_16x16x32_bf16 v[136:139], v[16:19], v[244:247], v[136:139]
    s_nop 0
    v_mfma_f32_16x16x32_bf16 v[140:143], v[20:23], v[244:247], v[140:143]
    v_mul_u32_u24 v28, 20, v6
    v_add_lshl_u32 v28, v28, v5, 4
    s_mul_i32 s74, s72, 5184
    v_add_u32 v28, s74, v28
    s_waitcnt vmcnt(0)
    s_setprio 3
    v_perm_b32 v8, v68, v64, s77
    v_perm_b32 v9, v76, v72, s77
    v_perm_b32 v10, v84, v80, s77
    v_perm_b32 v11, v92, v88, s77
    v_perm_b32 v12, v69, v65, s77
    v_perm_b32 v13, v77, v73, s77
    v_perm_b32 v14, v85, v81, s77
    v_perm_b32 v15, v93, v89, s77
    v_mfma_f32_16x16x32_bf16 v[128:131], v[8:11], v[248:251], v[128:131]
    v_perm_b32 v16, v70, v66, s77
    v_perm_b32 v17, v78, v74, s77
    v_perm_b32 v18, v86, v82, s77
    v_perm_b32 v19, v94, v90, s77
    v_mfma_f32_16x16x32_bf16 v[132:135], v[12:15], v[248:251], v[132:135]
    v_perm_b32 v20, v71, v67, s77
    v_perm_b32 v21, v79, v75, s77
    v_perm_b32 v22, v87, v83, s77
    v_perm_b32 v23, v95, v91, s77
    v_mfma_f32_16x16x32_bf16 v[136:139], v[16:19], v[248:251], v[136:139]
    v_perm_b32 v8, v68, v64, s78
    v_perm_b32 v9, v76, v72, s78
    v_perm_b32 v10, v84, v80, s78
    v_perm_b32 v11, v92, v88, s78
    v_mfma_f32_16x16x32_bf16 v[140:143], v[20:23], v[248:251], v[140:143]
    v_perm_b32 v12, v69, v65, s78
    v_perm_b32 v13, v77, v73, s78
    v_perm_b32 v14, v85, v81, s78
    v_perm_b32 v15, v93, v89, s78
    v_mfma_f32_16x16x32_bf16 v[128:131], v[8:11], v[252:255], v[128:131]
    v_perm_b32 v16, v70, v66, s78
    v_perm_b32 v17, v78, v74, s78
    v_perm_b32 v18, v86, v82, s78
    v_perm_b32 v19, v94, v90, s78
    v_mfma_f32_16x16x32_bf16 v[132:135], v[12:15], v[252:255], v[132:135]
    v_perm_b32 v20, v71, v67, s78
    v_perm_b32 v21, v79, v75, s78
    v_perm_b32 v22, v87, v83, s78
    v_perm_b32 v23, v95, v91, s78
    v_mfma_f32_16x16x32_bf16 v[136:139], v[16:19], v[252:255], v[136:139]
    s_nop 0
    v_mfma_f32_16x16x32_bf16 v[140:143], v[20:23], v[252:255], v[140:143]
    ds_write_b128 v28, v[128:131] offset:11008
    ds_write_b128 v28, v[132:135] offset:12304
    s_nop 3
    ds_write_b128 v28, v[136:139] offset:13600
    s_nop 0
    ds_write_b128 v28, v[140:143] offset:14896
    s_cmp_lg_u32 s72, 7
    s_cbranch_scc1 L_RKP
    s_mov_b64 exec, 1
    v_mov_b32 v29, 0
    s_waitcnt vmcnt(0)
    ds_write_b32 v29, v159 offset:10884
    s_mov_b64 exec, -1
L_RKP:
    v_mov_b32 v29, 0
    s_waitcnt lgkmcnt(0)
    s_barrier
    ds_read_b32 v159, v29 offset:10884
    s_cmp_ge_u32 s72, 4
    s_cbranch_scc1 L_W2
    v_and_b32 v28, 7, v0
    v_lshrrev_b32 v29, 1, v28
    v_mul_u32_u24 v29, 81, v29
    v_and_b32 v28, 1, v0
    v_lshl_add_u32 v29, v28, 3, v29
    v_bfe_u32 v28, v0, 3, 2
    v_mul_u32_u24 v28, 20, v28
    v_add_u32 v29, v28, v29
    v_lshrrev_b32 v28, 5, v0
    v_add_u32 v29, v28, v29
    s_lshl_b32 s74, s72, 1
    v_add_lshl_u32 v29, v29, s74, 4
    ds_read_b128 v[160:163], v29 offset:11008
    ds_read_b128 v[164:167], v29 offset:16192
    ds_read_b128 v[168:171], v29 offset:21376
    ds_read_b128 v[172:175], v29 offset:26560
    ds_read_b128 v[176:179], v29 offset:31744
    ds_read_b128 v[180:183], v29 offset:36928
    ds_read_b128 v[184:187], v29 offset:42112
    ds_read_b128 v[188:191], v29 offset:47296
    v_lshlrev_b32 v28, 14, v28
    v_and_b32 v29, 31, v0
    v_lshl_add_u32 v28, v29, 4, v28
    s_lshl_b32 s74, s72, 15
    s_add_u32 s74, s74, s84
    s_waitcnt lgkmcnt(0)
    v_pk_add_f32 v[160:161], v[160:161], v[176:177]
    v_pk_add_f32 v[162:163], v[162:163], v[178:179]
    v_pk_add_f32 v[164:165], v[164:165], v[180:181]
    v_pk_add_f32 v[166:167], v[166:167], v[182:183]
    v_pk_add_f32 v[168:169], v[168:169], v[184:185]
    v_pk_add_f32 v[170:171], v[170:171], v[186:187]
    v_pk_add_f32 v[172:173], v[172:173], v[188:189]
    v_pk_add_f32 v[174:175], v[174:175], v[190:191]
    v_pk_add_f32 v[160:161], v[160:161], v[168:169]
    v_pk_add_f32 v[162:163], v[162:163], v[170:171]
    v_pk_add_f32 v[164:165], v[164:165], v[172:173]
    v_pk_add_f32 v[166:167], v[166:167], v[174:175]
    v_pk_add_f32 v[160:161], v[160:161], v[164:165]
    v_pk_add_f32 v[162:163], v[162:163], v[166:167]
    v_bfi_b32 v160, v3, s56, v160
    v_bfi_b32 v161, v3, s57, v161
    v_bfi_b32 v162, v3, s58, v162
    v_bfi_b32 v163, v3, s59, v163
    buffer_store_dwordx4 v[160:163], v28, s[52:55], s74 offen sc1
    v_readfirstlane_b32 s30, v159
    s_nop 0
    s_and_b32 s30, s30, 0xff
    s_cmp_ge_u32 s30, 192
    s_nop 0
    s_cbranch_scc1 L_NOROLE
    s_lshr_b32 s8, s30, 1
    s_and_b32 s11, s8, 3
    s_lshl_b32 s8, s8, 16
    s_and_b32 s95, s30, 1
    s_lshl_b32 s95, s95, 10
    s_add_u32 s8, s8, s95
    s_lshl_b32 s95, s72, 8
    s_add_u32 s8, s8, s95
    s_lshr_b32 s10, s30, 3
    s_lshl_b32 s9, s10, 9
    s_add_u32 s9, s9, 0x200000
    s_lshl_b32 s10, s10, 14
    s_lshl_b32 s11, s11, 7
    s_add_u32 s10, s10, s11
    s_lshl_b32 s95, s72, 12
    s_add_u32 s10, s10, s95
    s_add_u32 s10, s10, 0x100000
    s_add_u32 s11, s10, 0x80000
    s_lshl_b32 s12, s30, 12
    s_lshl_b32 s95, s72, 10
    s_add_u32 s12, s12, s95
    s_add_u32 s12, s12, 0x300000
    s_cmp_lt_u32 s30, 64
    s_cbranch_scc1 L_DBL
    buffer_load_dwordx4 v[192:195], v30, s[52:55], s9 offen sc1
    s_add_u32 s95, s8, 0
    buffer_load_dwordx4 v[96:99], v4, s[48:51], s95 offen offset:0 nt
    s_add_u32 s95, s8, 16384
    buffer_load_dwordx4 v[100:103], v4, s[48:51], s95 offen offset:0 nt
    s_add_u32 s95, s8, 32768
    buffer_load_dwordx4 v[104:107], v4, s[48:51], s95 offen offset:0 nt
    s_add_u32 s95, s8, 49152
    buffer_load_dwordx4 v[108:111], v4, s[48:51], s95 offen offset:0 nt
    s_add_u32 s95, s8, 0
    buffer_load_dwordx4 v[112:115], v4, s[48:51], s95 offen offset:2048 nt
    s_add_u32 s95, s8, 16384
    buffer_load_dwordx4 v[116:119], v4, s[48:51], s95 offen offset:2048 nt
    s_add_u32 s95, s8, 32768
    buffer_load_dwordx4 v[120:123], v4, s[48:51], s95 offen offset:2048 nt
    s_add_u32 s95, s8, 49152
    buffer_load_dwordx4 v[124:127], v4, s[48:51], s95 offen offset:2048 nt
    buffer_load_dwordx4 v[200:203], v26, s[52:55], s10 offen sc1
    buffer_load_dwordx4 v[204:207], v26, s[52:55], s11 offen sc1
    s_mov_b32 s87, 0
    s_waitcnt vmcnt(10)
L_POLLM:
    v_cmp_ne_u32 vcc, s56, v194
    s_nop 3
    s_cbranch_vccz L_POLLM_DONE
    s_add_u32 s87, s87, 1
    s_cmp_gt_u32 s87, 0x20000
    s_cbranch_scc1 L_POLLM_DONE
    s_mov_b64 exec, vcc
    buffer_load_dwordx4 v[192:195], v30, s[52:55], s9 offen sc1
    s_mov_b64 exec, -1
    s_waitcnt vmcnt(0)
    s_nop 2
    s_branch L_POLLM
L_POLLM_DONE:
    v_lshrrev_b32 v28, 3, v0
    s_lshl_b32 s74, s72, 3
    v_add_lshl_u32 v28, v28, s74, 2
    v_mov_b32 v8, v192
    s_nop 1
    v_max_f32_dpp v8, v8, v8 row_ror:1 row_mask:0xf bank_mask:0xf
    s_nop 1
    v_max_f32_dpp v8, v8, v8 row_ror:2 row_mask:0xf bank_mask:0xf
    s_nop 1
    v_max_f32_dpp v8, v8, v8 row_ror:4 row_mask:0xf bank_mask:0xf
    s_nop 1
    v_max_f32_dpp v8, v8, v8 row_ror:8 row_mask:0xf bank_mask:0xf
    v_mov_b32 v9, v8
    s_nop 1
    v_permlane16_swap_b32 v8, v9
    v_max_f32 v8, v8, v9
    v_sub_f32 v192, v192, v8
    v_exp_f32 v192, v192
    s_nop 0
    v_mul_f32 v8, v192, v193
    s_nop 1
    v_add_f32_dpp v8, v8, v8 row_ror:1 row_mask:0xf bank_mask:0xf
    s_nop 1
    v_add_f32_dpp v8, v8, v8 row_ror:2 row_mask:0xf bank_mask:0xf
    s_nop 1
    v_add_f32_dpp v8, v8, v8 row_ror:4 row_mask:0xf bank_mask:0xf
    s_nop 1
    v_add_f32_dpp v8, v8, v8 row_ror:8 row_mask:0xf bank_mask:0xf
    v_mov_b32 v9, v8
    s_nop 1
    v_permlane16_swap_b32 v8, v9
    v_add_f32 v8, v8, v9
    v_rcp_f32 v8, v8
    s_nop 0
    v_mul_f32 v192, v192, v8
    ds_bpermute_b32 v196, v28, v192
    ds_bpermute_b32 v197, v28, v192 offset:128
    v_mov_b64 v[224:225], 0
    v_mov_b64 v[226:227], 0
    v_mov_b64 v[228:229], 0
    v_mov_b64 v[230:231], 0
    v_mov_b64 v[232:233], 0
    v_mov_b64 v[234:235], 0
    v_mov_b64 v[236:237], 0
    v_mov_b64 v[238:239], 0
    v_mov_b64 v[240:241], 0
    v_mov_b64 v[242:243], 0
    v_mov_b64 v[244:245], 0
    v_mov_b64 v[246:247], 0
    v_mov_b64 v[248:249], 0
    v_mov_b64 v[250:251], 0
    v_mov_b64 v[252:253], 0
    v_mov_b64 v[254:255], 0
    v_bfe_u32 v27, v0, 3, 1
    v_lshlrev_b32 v27, 1, v27
    v_bfe_u32 v29, v0, 4, 1
    v_add_u32 v27, v27, v29
    v_and_b32 v29, 1, v0
    v_lshl_add_u32 v27, v29, 2, v27
    v_bfe_u32 v29, v0, 1, 2
    v_lshl_add_u32 v27, v29, 3, v27
    v_lshrrev_b32 v29, 5, v0
    v_lshl_add_u32 v27, v29, 5, v27
    s_lshl_b32 s74, s72, 6
    v_add_lshl_u32 v27, v27, s74, 2
    v_and_b32 v29, 1, v0
    v_lshlrev_b32 v29, 7, v29
    v_lshl_add_u32 v29, v6, 5, v29
    v_and_b32 v23, 1, v0
    v_lshlrev_b32 v23, 9, v23
    v_lshl_add_u32 v23, v6, 7, v23
    v_lshrrev_b32 v22, 1, v5
    v_lshl_add_u32 v23, v22, 4, v23
    s_mov_b32 s98, 0xff00ff00
    s_mov_b32 s99, 0xff00ff00
    s_waitcnt vmcnt(2)
    v_perm_b32 v32, v100, v96, s77
    v_perm_b32 v33, v108, v104, s77
    v_perm_b32 v34, v116, v112, s77
    v_perm_b32 v35, v124, v120, s77
    v_perm_b32 v36, v100, v96, s78
    v_perm_b32 v37, v108, v104, s78
    v_perm_b32 v38, v116, v112, s78
    v_perm_b32 v39, v124, v120, s78
    v_perm_b32 v40, v101, v97, s77
    v_perm_b32 v41, v109, v105, s77
    v_perm_b32 v42, v117, v113, s77
    v_perm_b32 v43, v125, v121, s77
    v_perm_b32 v44, v101, v97, s78
    v_perm_b32 v45, v109, v105, s78
    v_perm_b32 v46, v117, v113, s78
    v_perm_b32 v47, v125, v121, s78
    v_perm_b32 v48, v102, v98, s77
    v_perm_b32 v49, v110, v106, s77
    v_perm_b32 v50, v118, v114, s77
    v_perm_b32 v51, v126, v122, s77
    v_perm_b32 v52, v102, v98, s78
    v_perm_b32 v53, v110, v106, s78
    v_perm_b32 v54, v118, v114, s78
    v_perm_b32 v55, v126, v122, s78
    v_perm_b32 v56, v103, v99, s77
    v_perm_b32 v57, v111, v107, s77
    v_perm_b32 v58, v119, v115, s77
    v_perm_b32 v59, v127, v123, s77
    v_perm_b32 v60, v103, v99, s78
    v_perm_b32 v61, v111, v107, s78
    v_perm_b32 v62, v119, v115, s78
    v_perm_b32 v63, v127, v123, s78
    s_mov_b32 s87, 0
L_POLL1:
    s_waitcnt vmcnt(0) lgkmcnt(0)
L_POLL1C:
    v_perm_b32 v8, v201, v200, s92
    v_perm_b32 v9, v203, v202, s93
    v_or_b32 v10, v8, v9
    v_xor_b32 v10, s56, v10
    v_perm_b32 v8, v205, v204, s92
    v_perm_b32 v9, v207, v206, s93
    v_or_b32 v8, v8, v9
    v_xor_b32 v8, s56, v8
    v_or_b32 v10, v10, v8
    v_cmp_ne_u32 vcc, 0, v10
    s_nop 3
    s_cbranch_vccz L_POLL1_DONE
    s_add_u32 s87, s87, 1
    s_cmp_gt_u32 s87, 0x40000
    s_cbranch_scc1 L_POLL1_DONE
    s_mov_b64 exec, vcc
    buffer_load_dwordx4 v[200:203], v26, s[52:55], s10 offen sc1
    buffer_load_dwordx4 v[204:207], v26, s[52:55], s11 offen sc1
    s_mov_b64 exec, -1
    s_bcnt1_i32_b64 s74, vcc
    s_cmp_gt_u32 s74, 32
    s_nop 1
    s_cbranch_scc1 L_POLL1
    s_waitcnt vmcnt(14)
    s_branch L_POLL1C
L_POLL1_DONE:
    v_pk_mul_f32 v[208:209], v[200:201], v[196:197] op_sel:[0,0] op_sel_hi:[1,0]
    v_pk_mul_f32 v[210:211], v[202:203], v[196:197] op_sel:[0,0] op_sel_hi:[1,0]
    v_pk_mul_f32 v[212:213], v[204:205], v[196:197] op_sel:[0,1] op_sel_hi:[1,1]
    v_pk_mul_f32 v[214:215], v[206:207], v[196:197] op_sel:[0,1] op_sel_hi:[1,1]
    s_nop 0
    v_permlane32_swap_b32 v208, v212
    v_permlane32_swap_b32 v209, v213
    v_permlane32_swap_b32 v210, v214
    v_permlane32_swap_b32 v211, v215
    v_pk_add_f32 v[208:209], v[208:209], v[212:213]
    v_pk_add_f32 v[210:211], v[210:211], v[214:215]
    s_nop 0
    v_permlane16_swap_b32 v208, v209
    v_permlane16_swap_b32 v210, v211
    v_add_f32 v208, v208, v209
    v_add_f32 v210, v210, v211
    s_nop 0
    v_add_f32_dpp v208, v208, v208 row_ror:8 row_mask:0xf bank_mask:0xf
    v_add_f32_dpp v210, v210, v210 row_ror:8 row_mask:0xf bank_mask:0xf
    v_cndmask_b32 v208, v208, v210, s[98:99]
    ds_write_b32 v27, v208 offset:0
    s_waitcnt lgkmcnt(0)
    s_barrier
    ds_read_b128 v[160:163], v29 offset:0
    ds_read_b128 v[164:167], v29 offset:16
    ds_read_b128 v[168:171], v29 offset:256
    ds_read_b128 v[172:175], v29 offset:272
    ds_read_b128 v[176:179], v29 offset:512
    ds_read_b128 v[180:183], v29 offset:528
    ds_read_b128 v[184:187], v29 offset:768
    ds_read_b128 v[188:191], v29 offset:784
    s_waitcnt lgkmcnt(4)
    v_pk_add_f32 v[160:161], v[160:161], v[168:169]
    v_pk_add_f32 v[162:163], v[162:163], v[170:171]
    v_pk_add_f32 v[164:165], v[164:165], v[172:173]
    v_pk_add_f32 v[166:167], v[166:167], v[174:175]
    s_waitcnt lgkmcnt(0)
    v_pk_add_f32 v[176:177], v[176:177], v[184:185]
    v_pk_add_f32 v[178:179], v[178:179], v[186:187]
    v_pk_add_f32 v[180:181], v[180:181], v[188:189]
    v_pk_add_f32 v[182:183], v[182:183], v[190:191]
    v_pk_add_f32 v[160:161], v[160:161], v[176:177]
    v_pk_add_f32 v[162:163], v[162:163], v[178:179]
    v_pk_add_f32 v[164:165], v[164:165], v[180:181]
    v_pk_add_f32 v[166:167], v[166:167], v[182:183]
    v_cvt_pk_bf16_f32 v24, v160, v161
    v_cvt_pk_bf16_f32 v25, v162, v163
    v_cvt_pk_bf16_f32 v26, v164, v165
    v_cvt_pk_bf16_f32 v27, v166, v167
    s_lshl_b64 exec, s[80:81], 0
    v_mov_b64 v[224:225], v[24:25]
    v_mov_b64 v[226:227], v[26:27]
    s_lshl_b64 exec, s[80:81], 2
    v_mov_b64 v[228:229], v[24:25]
    v_mov_b64 v[230:231], v[26:27]
    s_lshl_b64 exec, s[80:81], 4
    v_mov_b64 v[232:233], v[24:25]
    v_mov_b64 v[234:235], v[26:27]
    s_lshl_b64 exec, s[80:81], 6
    v_mov_b64 v[236:237], v[24:25]
    v_mov_b64 v[238:239], v[26:27]
    s_lshl_b64 exec, s[80:81], 8
    v_mov_b64 v[240:241], v[24:25]
    v_mov_b64 v[242:243], v[26:27]
    s_lshl_b64 exec, s[80:81], 10
    v_mov_b64 v[244:245], v[24:25]
    v_mov_b64 v[246:247], v[26:27]
    s_lshl_b64 exec, s[80:81], 12
    v_mov_b64 v[248:249], v[24:25]
    v_mov_b64 v[250:251], v[26:27]
    s_lshl_b64 exec, s[80:81], 14
    v_mov_b64 v[252:253], v[24:25]
    v_mov_b64 v[254:255], v[26:27]
    s_mov_b64 exec, -1
    s_nop 3
    v_mfma_f32_16x16x32_bf16 v[128:131], v[32:35], v[224:227], 0
    v_mfma_f32_16x16x32_bf16 v[132:135], v[36:39], v[228:231], 0
    v_mfma_f32_16x16x32_bf16 v[128:131], v[40:43], v[232:235], v[128:131]
    v_mfma_f32_16x16x32_bf16 v[132:135], v[44:47], v[236:239], v[132:135]
    v_mfma_f32_16x16x32_bf16 v[128:131], v[48:51], v[240:243], v[128:131]
    v_mfma_f32_16x16x32_bf16 v[132:135], v[52:55], v[244:247], v[132:135]
    v_mfma_f32_16x16x32_bf16 v[128:131], v[56:59], v[248:251], v[128:131]
    v_mfma_f32_16x16x32_bf16 v[132:135], v[60:63], v[252:255], v[132:135]
    s_nop 7
    v_pk_add_f32 v[128:129], v[128:129], v[132:133]
    v_pk_add_f32 v[130:131], v[130:131], v[134:135]
    v_bfi_b32 v128, v3, s56, v128
    v_bfi_b32 v129, v3, s57, v129
    v_bfi_b32 v130, v3, s58, v130
    v_bfi_b32 v131, v3, s59, v131
    buffer_store_dwordx4 v[128:131], v23, s[52:55], s12 offen sc1
    s_nop 0
    s_branch L_DONE
L_DBL:
    s_add_u32 s30, s30, 192
    s_lshr_b32 s13, s30, 1
    s_and_b32 s16, s13, 3
    s_lshl_b32 s13, s13, 16
    s_and_b32 s95, s30, 1
    s_lshl_b32 s95, s95, 10
    s_add_u32 s13, s13, s95
    s_lshl_b32 s95, s72, 8
    s_add_u32 s13, s13, s95
    s_lshr_b32 s15, s30, 3
    s_lshl_b32 s14, s15, 9
    s_add_u32 s14, s14, 0x200000
    s_lshl_b32 s15, s15, 14
    s_lshl_b32 s16, s16, 7
    s_add_u32 s15, s15, s16
    s_lshl_b32 s95, s72, 12
    s_add_u32 s15, s15, s95
    s_add_u32 s15, s15, 0x100000
    s_add_u32 s16, s15, 0x80000
    s_lshl_b32 s17, s30, 12
    s_lshl_b32 s95, s72, 10
    s_add_u32 s17, s17, s95
    s_add_u32 s17, s17, 0x300000
    buffer_load_dwordx4 v[192:195], v30, s[52:55], s9 offen sc1
    buffer_load_dwordx4 v[144:147], v30, s[52:55], s14 offen sc1
    s_add_u32 s95, s8, 0
    buffer_load_dwordx4 v[96:99], v4, s[48:51], s95 offen offset:0 nt
    s_add_u32 s95, s8, 16384
    buffer_load_dwordx4 v[100:103], v4, s[48:51], s95 offen offset:0 nt
    s_add_u32 s95, s8, 32768
    buffer_load_dwordx4 v[104:107], v4, s[48:51], s95 offen offset:0 nt
    s_add_u32 s95, s8, 49152
    buffer_load_dwordx4 v[108:111], v4, s[48:51], s95 offen offset:0 nt
    s_add_u32 s95, s8, 0
    buffer_load_dwordx4 v[112:115], v4, s[48:51], s95 offen offset:2048 nt
    s_add_u32 s95, s8, 16384
    buffer_load_dwordx4 v[116:119], v4, s[48:51], s95 offen offset:2048 nt
    s_add_u32 s95, s8, 32768
    buffer_load_dwordx4 v[120:123], v4, s[48:51], s95 offen offset:2048 nt
    s_add_u32 s95, s8, 49152
    buffer_load_dwordx4 v[124:127], v4, s[48:51], s95 offen offset:2048 nt
    s_add_u32 s95, s13, 0
    buffer_load_dwordx4 v[64:67], v4, s[48:51], s95 offen offset:0 nt
    s_add_u32 s95, s13, 16384
    buffer_load_dwordx4 v[68:71], v4, s[48:51], s95 offen offset:0 nt
    s_add_u32 s95, s13, 32768
    buffer_load_dwordx4 v[72:75], v4, s[48:51], s95 offen offset:0 nt
    s_add_u32 s95, s13, 49152
    buffer_load_dwordx4 v[76:79], v4, s[48:51], s95 offen offset:0 nt
    s_add_u32 s95, s13, 0
    buffer_load_dwordx4 v[80:83], v4, s[48:51], s95 offen offset:2048 nt
    s_add_u32 s95, s13, 16384
    buffer_load_dwordx4 v[84:87], v4, s[48:51], s95 offen offset:2048 nt
    s_add_u32 s95, s13, 32768
    buffer_load_dwordx4 v[88:91], v4, s[48:51], s95 offen offset:2048 nt
    s_add_u32 s95, s13, 49152
    buffer_load_dwordx4 v[92:95], v4, s[48:51], s95 offen offset:2048 nt
    buffer_load_dwordx4 v[200:203], v26, s[52:55], s10 offen sc1
    buffer_load_dwordx4 v[204:207], v26, s[52:55], s11 offen sc1
    buffer_load_dwordx4 v[216:219], v26, s[52:55], s15 offen sc1
    buffer_load_dwordx4 v[220:223], v26, s[52:55], s16 offen sc1
    s_mov_b32 s87, 0
    s_waitcnt vmcnt(20)
L_POLLMD:
    v_cmp_ne_u32 vcc, s56, v194
    v_cmp_ne_u32 s[98:99], s56, v146
    s_nop 0
    s_or_b64 vcc, vcc, s[98:99]
    s_nop 1
    s_cbranch_vccz L_POLLM_DONED
    s_add_u32 s87, s87, 1
    s_cmp_gt_u32 s87, 0x20000
    s_cbranch_scc1 L_POLLM_DONED
    s_mov_b64 exec, vcc
    buffer_load_dwordx4 v[192:195], v30, s[52:55], s9 offen sc1
    buffer_load_dwordx4 v[144:147], v30, s[52:55], s14 offen sc1
    s_mov_b64 exec, -1
    s_waitcnt vmcnt(0)
    s_nop 2
    s_branch L_POLLMD
L_POLLM_DONED:
    v_lshrrev_b32 v28, 3, v0
    s_lshl_b32 s74, s72, 3
    v_add_lshl_u32 v28, v28, s74, 2
    v_mov_b32 v8, v192
    s_nop 1
    v_max_f32_dpp v8, v8, v8 row_ror:1 row_mask:0xf bank_mask:0xf
    s_nop 1
    v_max_f32_dpp v8, v8, v8 row_ror:2 row_mask:0xf bank_mask:0xf
    s_nop 1
    v_max_f32_dpp v8, v8, v8 row_ror:4 row_mask:0xf bank_mask:0xf
    s_nop 1
    v_max_f32_dpp v8, v8, v8 row_ror:8 row_mask:0xf bank_mask:0xf
    v_mov_b32 v9, v8
    s_nop 1
    v_permlane16_swap_b32 v8, v9
    v_max_f32 v8, v8, v9
    v_sub_f32 v192, v192, v8
    v_exp_f32 v192, v192
    s_nop 0
    v_mul_f32 v8, v192, v193
    s_nop 1
    v_add_f32_dpp v8, v8, v8 row_ror:1 row_mask:0xf bank_mask:0xf
    s_nop 1
    v_add_f32_dpp v8, v8, v8 row_ror:2 row_mask:0xf bank_mask:0xf
    s_nop 1
    v_add_f32_dpp v8, v8, v8 row_ror:4 row_mask:0xf bank_mask:0xf
    s_nop 1
    v_add_f32_dpp v8, v8, v8 row_ror:8 row_mask:0xf bank_mask:0xf
    v_mov_b32 v9, v8
    s_nop 1
    v_permlane16_swap_b32 v8, v9
    v_add_f32 v8, v8, v9
    v_rcp_f32 v8, v8
    s_nop 0
    v_mul_f32 v192, v192, v8
    ds_bpermute_b32 v196, v28, v192
    ds_bpermute_b32 v197, v28, v192 offset:128
    v_mov_b32 v8, v144
    s_nop 1
    v_max_f32_dpp v8, v8, v8 row_ror:1 row_mask:0xf bank_mask:0xf
    s_nop 1
    v_max_f32_dpp v8, v8, v8 row_ror:2 row_mask:0xf bank_mask:0xf
    s_nop 1
    v_max_f32_dpp v8, v8, v8 row_ror:4 row_mask:0xf bank_mask:0xf
    s_nop 1
    v_max_f32_dpp v8, v8, v8 row_ror:8 row_mask:0xf bank_mask:0xf
    v_mov_b32 v9, v8
    s_nop 1
    v_permlane16_swap_b32 v8, v9
    v_max_f32 v8, v8, v9
    v_sub_f32 v144, v144, v8
    v_exp_f32 v144, v144
    s_nop 0
    v_mul_f32 v8, v144, v145
    s_nop 1
    v_add_f32_dpp v8, v8, v8 row_ror:1 row_mask:0xf bank_mask:0xf
    s_nop 1
    v_add_f32_dpp v8, v8, v8 row_ror:2 row_mask:0xf bank_mask:0xf
    s_nop 1
    v_add_f32_dpp v8, v8, v8 row_ror:4 row_mask:0xf bank_mask:0xf
    s_nop 1
    v_add_f32_dpp v8, v8, v8 row_ror:8 row_mask:0xf bank_mask:0xf
    v_mov_b32 v9, v8
    s_nop 1
    v_permlane16_swap_b32 v8, v9
    v_add_f32 v8, v8, v9
    v_rcp_f32 v8, v8
    s_nop 0
    v_mul_f32 v144, v144, v8
    ds_bpermute_b32 v148, v28, v144
    ds_bpermute_b32 v149, v28, v144 offset:128
    v_mov_b64 v[224:225], 0
    v_mov_b64 v[226:227], 0
    v_mov_b64 v[228:229], 0
    v_mov_b64 v[230:231], 0
    v_mov_b64 v[232:233], 0
    v_mov_b64 v[234:235], 0
    v_mov_b64 v[236:237], 0
    v_mov_b64 v[238:239], 0
    v_mov_b64 v[240:241], 0
    v_mov_b64 v[242:243], 0
    v_mov_b64 v[244:245], 0
    v_mov_b64 v[246:247], 0
    v_mov_b64 v[248:249], 0
    v_mov_b64 v[250:251], 0
    v_mov_b64 v[252:253], 0
    v_mov_b64 v[254:255], 0
    v_bfe_u32 v27, v0, 3, 1
    v_lshlrev_b32 v27, 1, v27
    v_bfe_u32 v29, v0, 4, 1
    v_add_u32 v27, v27, v29
    v_and_b32 v29, 1, v0
    v_lshl_add_u32 v27, v29, 2, v27
    v_bfe_u32 v29, v0, 1, 2
    v_lshl_add_u32 v27, v29, 3, v27
    v_lshrrev_b32 v29, 5, v0
    v_lshl_add_u32 v27, v29, 5, v27
    s_lshl_b32 s74, s72, 6
    v_add_lshl_u32 v27, v27, s74, 2
    v_and_b32 v29, 1, v0
    v_lshlrev_b32 v29, 7, v29
    v_lshl_add_u32 v29, v6, 5, v29
    v_and_b32 v23, 1, v0
    v_lshlrev_b32 v23, 9, v23
    v_lshl_add_u32 v23, v6, 7, v23
    v_lshrrev_b32 v22, 1, v5
    v_lshl_add_u32 v23, v22, 4, v23
    s_mov_b32 s98, 0xff00ff00
    s_mov_b32 s99, 0xff00ff00
    s_waitcnt vmcnt(4)
    v_perm_b32 v32, v100, v96, s77
    v_perm_b32 v33, v108, v104, s77
    v_perm_b32 v34, v116, v112, s77
    v_perm_b32 v35, v124, v120, s77
    v_perm_b32 v36, v100, v96, s78
    v_perm_b32 v37, v108, v104, s78
    v_perm_b32 v38, v116, v112, s78
    v_perm_b32 v39, v124, v120, s78
    v_perm_b32 v40, v101, v97, s77
    v_perm_b32 v41, v109, v105, s77
    v_perm_b32 v42, v117, v113, s77
    v_perm_b32 v43, v125, v121, s77
    v_perm_b32 v44, v101, v97, s78
    v_perm_b32 v45, v109, v105, s78
    v_perm_b32 v46, v117, v113, s78
    v_perm_b32 v47, v125, v121, s78
    v_perm_b32 v48, v102, v98, s77
    v_perm_b32 v49, v110, v106, s77
    v_perm_b32 v50, v118, v114, s77
    v_perm_b32 v51, v126, v122, s77
    v_perm_b32 v52, v102, v98, s78
    v_perm_b32 v53, v110, v106, s78
    v_perm_b32 v54, v118, v114, s78
    v_perm_b32 v55, v126, v122, s78
    v_perm_b32 v56, v103, v99, s77
    v_perm_b32 v57, v111, v107, s77
    v_perm_b32 v58, v119, v115, s77
    v_perm_b32 v59, v127, v123, s77
    v_perm_b32 v60, v103, v99, s78
    v_perm_b32 v61, v111, v107, s78
    v_perm_b32 v62, v119, v115, s78
    v_perm_b32 v63, v127, v123, s78
    v_perm_b32 v96, v68, v64, s77
    v_perm_b32 v97, v76, v72, s77
    v_perm_b32 v98, v84, v80, s77
    v_perm_b32 v99, v92, v88, s77
    v_perm_b32 v100, v68, v64, s78
    v_perm_b32 v101, v76, v72, s78
    v_perm_b32 v102, v84, v80, s78
    v_perm_b32 v103, v92, v88, s78
    v_perm_b32 v104, v69, v65, s77
    v_perm_b32 v105, v77, v73, s77
    v_perm_b32 v106, v85, v81, s77
    v_perm_b32 v107, v93, v89, s77
    v_perm_b32 v108, v69, v65, s78
    v_perm_b32 v109, v77, v73, s78
    v_perm_b32 v110, v85, v81, s78
    v_perm_b32 v111, v93, v89, s78
    v_perm_b32 v112, v70, v66, s77
    v_perm_b32 v113, v78, v74, s77
    v_perm_b32 v114, v86, v82, s77
    v_perm_b32 v115, v94, v90, s77
    v_perm_b32 v116, v70, v66, s78
    v_perm_b32 v117, v78, v74, s78
    v_perm_b32 v118, v86, v82, s78
    v_perm_b32 v119, v94, v90, s78
    v_perm_b32 v120, v71, v67, s77
    v_perm_b32 v121, v79, v75, s77
    v_perm_b32 v122, v87, v83, s77
    v_perm_b32 v123, v95, v91, s77
    v_perm_b32 v124, v71, v67, s78
    v_perm_b32 v125, v79, v75, s78
    v_perm_b32 v126, v87, v83, s78
    v_perm_b32 v127, v95, v91, s78
    v_mov_b64 v[64:65], 0
    v_mov_b64 v[66:67], 0
    v_mov_b64 v[68:69], 0
    v_mov_b64 v[70:71], 0
    v_mov_b64 v[72:73], 0
    v_mov_b64 v[74:75], 0
    v_mov_b64 v[76:77], 0
    v_mov_b64 v[78:79], 0
    v_mov_b64 v[80:81], 0
    v_mov_b64 v[82:83], 0
    v_mov_b64 v[84:85], 0
    v_mov_b64 v[86:87], 0
    v_mov_b64 v[88:89], 0
    v_mov_b64 v[90:91], 0
    v_mov_b64 v[92:93], 0
    v_mov_b64 v[94:95], 0
    s_mov_b32 s87, 0
L_POLL1D:
    s_waitcnt vmcnt(0) lgkmcnt(0)
L_POLL1CD:
    v_perm_b32 v8, v201, v200, s92
    v_perm_b32 v9, v203, v202, s93
    v_or_b32 v10, v8, v9
    v_xor_b32 v10, s56, v10
    v_perm_b32 v8, v205, v204, s92
    v_perm_b32 v9, v207, v206, s93
    v_or_b32 v8, v8, v9
    v_xor_b32 v8, s56, v8
    v_or_b32 v10, v10, v8
    v_perm_b32 v8, v217, v216, s92
    v_perm_b32 v9, v219, v218, s93
    v_or_b32 v8, v8, v9
    v_xor_b32 v8, s56, v8
    v_or_b32 v10, v10, v8
    v_perm_b32 v8, v221, v220, s92
    v_perm_b32 v9, v223, v222, s93
    v_or_b32 v8, v8, v9
    v_xor_b32 v8, s56, v8
    v_or_b32 v10, v10, v8
    v_cmp_ne_u32 vcc, 0, v10
    s_nop 3
    s_cbranch_vccz L_POLL1_DONED
    s_add_u32 s87, s87, 1
    s_cmp_gt_u32 s87, 0x40000
    s_cbranch_scc1 L_POLL1_DONED
    s_mov_b64 exec, vcc
    buffer_load_dwordx4 v[200:203], v26, s[52:55], s10 offen sc1
    buffer_load_dwordx4 v[204:207], v26, s[52:55], s11 offen sc1
    buffer_load_dwordx4 v[216:219], v26, s[52:55], s15 offen sc1
    buffer_load_dwordx4 v[220:223], v26, s[52:55], s16 offen sc1
    s_mov_b64 exec, -1
    s_bcnt1_i32_b64 s74, vcc
    s_cmp_gt_u32 s74, 32
    s_nop 1
    s_cbranch_scc1 L_POLL1D
    s_waitcnt vmcnt(28)
    s_branch L_POLL1CD
L_POLL1_DONED:
    v_pk_mul_f32 v[208:209], v[200:201], v[196:197] op_sel:[0,0] op_sel_hi:[1,0]
    v_pk_mul_f32 v[150:151], v[216:217], v[148:149] op_sel:[0,0] op_sel_hi:[1,0]
    v_pk_mul_f32 v[210:211], v[202:203], v[196:197] op_sel:[0,0] op_sel_hi:[1,0]
    v_pk_mul_f32 v[152:153], v[218:219], v[148:149] op_sel:[0,0] op_sel_hi:[1,0]
    v_pk_mul_f32 v[212:213], v[204:205], v[196:197] op_sel:[0,1] op_sel_hi:[1,1]
    v_pk_mul_f32 v[154:155], v[220:221], v[148:149] op_sel:[0,1] op_sel_hi:[1,1]
    v_pk_mul_f32 v[214:215], v[206:207], v[196:197] op_sel:[0,1] op_sel_hi:[1,1]
    v_pk_mul_f32 v[156:157], v[222:223], v[148:149] op_sel:[0,1] op_sel_hi:[1,1]
    v_permlane32_swap_b32 v208, v212
    v_permlane32_swap_b32 v150, v154
    v_permlane32_swap_b32 v209, v213
    v_permlane32_swap_b32 v151, v155
    v_permlane32_swap_b32 v210, v214
    v_permlane32_swap_b32 v152, v156
    v_permlane32_swap_b32 v211, v215
    v_permlane32_swap_b32 v153, v157
    v_pk_add_f32 v[208:209], v[208:209], v[212:213]
    v_pk_add_f32 v[150:151], v[150:151], v[154:155]
    v_pk_add_f32 v[210:211], v[210:211], v[214:215]
    v_pk_add_f32 v[152:153], v[152:153], v[156:157]
    v_permlane16_swap_b32 v208, v209
    v_permlane16_swap_b32 v150, v151
    v_permlane16_swap_b32 v210, v211
    v_permlane16_swap_b32 v152, v153
    v_add_f32 v208, v208, v209
    v_add_f32 v150, v150, v151
    v_add_f32 v210, v210, v211
    v_add_f32 v152, v152, v153
    v_add_f32_dpp v208, v208, v208 row_ror:8 row_mask:0xf bank_mask:0xf
    v_add_f32_dpp v150, v150, v150 row_ror:8 row_mask:0xf bank_mask:0xf
    v_add_f32_dpp v210, v210, v210 row_ror:8 row_mask:0xf bank_mask:0xf
    v_add_f32_dpp v152, v152, v152 row_ror:8 row_mask:0xf bank_mask:0xf
    v_cndmask_b32 v208, v208, v210, s[98:99]
    v_cndmask_b32 v150, v150, v152, s[98:99]
    ds_write_b32 v27, v208 offset:0
    ds_write_b32 v27, v150 offset:1024
    s_waitcnt lgkmcnt(0)
    s_barrier
    ds_read_b128 v[160:163], v29 offset:0
    ds_read_b128 v[164:167], v29 offset:16
    ds_read_b128 v[168:171], v29 offset:256
    ds_read_b128 v[172:175], v29 offset:272
    ds_read_b128 v[176:179], v29 offset:512
    ds_read_b128 v[180:183], v29 offset:528
    ds_read_b128 v[184:187], v29 offset:768
    ds_read_b128 v[188:191], v29 offset:784
    ds_read_b128 v[192:195], v29 offset:1024
    ds_read_b128 v[196:199], v29 offset:1040
    ds_read_b128 v[208:211], v29 offset:1280
    ds_read_b128 v[212:215], v29 offset:1296
    ds_read_b128 v[144:147], v29 offset:1536
    ds_read_b128 v[148:151], v29 offset:1552
    ds_read_b128 v[152:155], v29 offset:1792
    ds_read_b128 v[12:15], v29 offset:1808
    s_waitcnt lgkmcnt(12)
    v_pk_add_f32 v[160:161], v[160:161], v[168:169]
    v_pk_add_f32 v[162:163], v[162:163], v[170:171]
    v_pk_add_f32 v[164:165], v[164:165], v[172:173]
    v_pk_add_f32 v[166:167], v[166:167], v[174:175]
    s_waitcnt lgkmcnt(8)
    v_pk_add_f32 v[176:177], v[176:177], v[184:185]
    v_pk_add_f32 v[178:179], v[178:179], v[186:187]
    v_pk_add_f32 v[180:181], v[180:181], v[188:189]
    v_pk_add_f32 v[182:183], v[182:183], v[190:191]
    v_pk_add_f32 v[160:161], v[160:161], v[176:177]
    v_pk_add_f32 v[162:163], v[162:163], v[178:179]
    v_pk_add_f32 v[164:165], v[164:165], v[180:181]
    v_pk_add_f32 v[166:167], v[166:167], v[182:183]
    v_cvt_pk_bf16_f32 v24, v160, v161
    v_cvt_pk_bf16_f32 v25, v162, v163
    v_cvt_pk_bf16_f32 v26, v164, v165
    v_cvt_pk_bf16_f32 v27, v166, v167
    s_lshl_b64 exec, s[80:81], 0
    v_mov_b64 v[224:225], v[24:25]
    v_mov_b64 v[226:227], v[26:27]
    s_lshl_b64 exec, s[80:81], 2
    v_mov_b64 v[228:229], v[24:25]
    v_mov_b64 v[230:231], v[26:27]
    s_lshl_b64 exec, s[80:81], 4
    v_mov_b64 v[232:233], v[24:25]
    v_mov_b64 v[234:235], v[26:27]
    s_lshl_b64 exec, s[80:81], 6
    v_mov_b64 v[236:237], v[24:25]
    v_mov_b64 v[238:239], v[26:27]
    s_lshl_b64 exec, s[80:81], 8
    v_mov_b64 v[240:241], v[24:25]
    v_mov_b64 v[242:243], v[26:27]
    s_lshl_b64 exec, s[80:81], 10
    v_mov_b64 v[244:245], v[24:25]
    v_mov_b64 v[246:247], v[26:27]
    s_lshl_b64 exec, s[80:81], 12
    v_mov_b64 v[248:249], v[24:25]
    v_mov_b64 v[250:251], v[26:27]
    s_lshl_b64 exec, s[80:81], 14
    v_mov_b64 v[252:253], v[24:25]
    v_mov_b64 v[254:255], v[26:27]
    s_mov_b64 exec, -1
    s_nop 3
    v_mfma_f32_16x16x32_bf16 v[128:131], v[32:35], v[224:227], 0
    v_mfma_f32_16x16x32_bf16 v[132:135], v[36:39], v[228:231], 0
    v_mfma_f32_16x16x32_bf16 v[128:131], v[40:43], v[232:235], v[128:131]
    v_mfma_f32_16x16x32_bf16 v[132:135], v[44:47], v[236:239], v[132:135]
    v_mfma_f32_16x16x32_bf16 v[128:131], v[48:51], v[240:243], v[128:131]
    v_mfma_f32_16x16x32_bf16 v[132:135], v[52:55], v[244:247], v[132:135]
    v_mfma_f32_16x16x32_bf16 v[128:131], v[56:59], v[248:251], v[128:131]
    v_mfma_f32_16x16x32_bf16 v[132:135], v[60:63], v[252:255], v[132:135]
    s_waitcnt lgkmcnt(4)
    v_pk_add_f32 v[192:193], v[192:193], v[208:209]
    v_pk_add_f32 v[194:195], v[194:195], v[210:211]
    v_pk_add_f32 v[196:197], v[196:197], v[212:213]
    v_pk_add_f32 v[198:199], v[198:199], v[214:215]
    s_waitcnt lgkmcnt(0)
    v_pk_add_f32 v[144:145], v[144:145], v[152:153]
    v_pk_add_f32 v[146:147], v[146:147], v[154:155]
    v_pk_add_f32 v[148:149], v[148:149], v[12:13]
    v_pk_add_f32 v[150:151], v[150:151], v[14:15]
    v_pk_add_f32 v[192:193], v[192:193], v[144:145]
    v_pk_add_f32 v[194:195], v[194:195], v[146:147]
    v_pk_add_f32 v[196:197], v[196:197], v[148:149]
    v_pk_add_f32 v[198:199], v[198:199], v[150:151]
    v_cvt_pk_bf16_f32 v8, v192, v193
    v_cvt_pk_bf16_f32 v9, v194, v195
    v_cvt_pk_bf16_f32 v10, v196, v197
    v_cvt_pk_bf16_f32 v11, v198, v199
    s_lshl_b64 exec, s[80:81], 0
    v_mov_b64 v[64:65], v[8:9]
    v_mov_b64 v[66:67], v[10:11]
    s_lshl_b64 exec, s[80:81], 2
    v_mov_b64 v[68:69], v[8:9]
    v_mov_b64 v[70:71], v[10:11]
    s_lshl_b64 exec, s[80:81], 4
    v_mov_b64 v[72:73], v[8:9]
    v_mov_b64 v[74:75], v[10:11]
    s_lshl_b64 exec, s[80:81], 6
    v_mov_b64 v[76:77], v[8:9]
    v_mov_b64 v[78:79], v[10:11]
    s_lshl_b64 exec, s[80:81], 8
    v_mov_b64 v[80:81], v[8:9]
    v_mov_b64 v[82:83], v[10:11]
    s_lshl_b64 exec, s[80:81], 10
    v_mov_b64 v[84:85], v[8:9]
    v_mov_b64 v[86:87], v[10:11]
    s_lshl_b64 exec, s[80:81], 12
    v_mov_b64 v[88:89], v[8:9]
    v_mov_b64 v[90:91], v[10:11]
    s_lshl_b64 exec, s[80:81], 14
    v_mov_b64 v[92:93], v[8:9]
    v_mov_b64 v[94:95], v[10:11]
    s_mov_b64 exec, -1
    s_nop 3
    v_mfma_f32_16x16x32_bf16 v[136:139], v[96:99], v[64:67], 0
    v_mfma_f32_16x16x32_bf16 v[140:143], v[100:103], v[68:71], 0
    v_mfma_f32_16x16x32_bf16 v[136:139], v[104:107], v[72:75], v[136:139]
    v_mfma_f32_16x16x32_bf16 v[140:143], v[108:111], v[76:79], v[140:143]
    v_mfma_f32_16x16x32_bf16 v[136:139], v[112:115], v[80:83], v[136:139]
    v_mfma_f32_16x16x32_bf16 v[140:143], v[116:119], v[84:87], v[140:143]
    v_mfma_f32_16x16x32_bf16 v[136:139], v[120:123], v[88:91], v[136:139]
    v_mfma_f32_16x16x32_bf16 v[140:143], v[124:127], v[92:95], v[140:143]
    v_pk_add_f32 v[128:129], v[128:129], v[132:133]
    v_pk_add_f32 v[130:131], v[130:131], v[134:135]
    v_bfi_b32 v128, v3, s56, v128
    v_bfi_b32 v129, v3, s57, v129
    v_bfi_b32 v130, v3, s58, v130
    v_bfi_b32 v131, v3, s59, v131
    buffer_store_dwordx4 v[128:131], v23, s[52:55], s12 offen sc1
    s_nop 0
    v_pk_add_f32 v[136:137], v[136:137], v[140:141]
    v_pk_add_f32 v[138:139], v[138:139], v[142:143]
    v_bfi_b32 v136, v3, s56, v136
    v_bfi_b32 v137, v3, s57, v137
    v_bfi_b32 v138, v3, s58, v138
    v_bfi_b32 v139, v3, s59, v139
    buffer_store_dwordx4 v[136:139], v23, s[52:55], s17 offen sc1
    s_nop 0
    s_branch L_DONE
L_NOROLE:
    s_barrier
    s_branch L_DONE
L_W2:
    s_setprio 3
    s_waitcnt lgkmcnt(0)
    v_readfirstlane_b32 s30, v159
    s_nop 0
    s_and_b32 s30, s30, 0xff
    s_cmp_lt_u32 s30, 224
    s_cselect_b32 s50, 0x700000, 0
    s_cselect_b32 s66, 7168, 0
    s_lshr_b32 s31, s30, 3
    s_and_b32 s75, s72, 3
    s_lshl_b32 s79, s31, 18
    s_lshl_b32 s95, s75, 16
    s_add_u32 s79, s79, s95
    s_and_b32 s95, s30, 7
    s_lshl_b32 s95, s95, 8
    s_add_u32 s79, s79, s95
    v_lshrrev_b32 v30, 1, v5
    v_and_b32 v30, 3, v30
    v_lshlrev_b32 v30, 10, v30
    v_and_b32 v27, 1, v0
    v_lshl_add_u32 v30, v27, 9, v30
    v_lshl_add_u32 v30, v6, 5, v30
    s_lshl_b32 s85, s31, 12
    s_and_b32 s75, s72, 3
    s_lshl_b32 s95, s75, 7
    s_add_u32 s85, s85, s95
    s_add_u32 s85, s85, 0x20000
    buffer_load_dwordx4 v[144:147], v30, s[52:55], s85 offen sc1
    buffer_load_dwordx4 v[148:151], v30, s[52:55], s85 offen offset:16 sc1
    s_lshl_b32 s74, s31, 8
    s_lshl_b32 s95, s75, 6
    s_add_u32 s74, s74, s95
    v_lshlrev_b32 v27, 2, v6
    buffer_load_dword v152, v27, s[64:67], s74 offen offset:0
    buffer_load_dword v153, v27, s[64:67], s74 offen offset:16
    buffer_load_dword v154, v27, s[64:67], s74 offen offset:32
    buffer_load_dword v155, v27, s[64:67], s74 offen offset:48
    s_add_u32 s95, s79, 0
    buffer_load_dwordx4 v[96:99], v4, s[48:51], s95 offen offset:0 nt
    s_add_u32 s95, s79, 16384
    buffer_load_dwordx4 v[100:103], v4, s[48:51], s95 offen offset:0 nt
    s_add_u32 s95, s79, 32768
    buffer_load_dwordx4 v[104:107], v4, s[48:51], s95 offen offset:0 nt
    s_add_u32 s95, s79, 49152
    buffer_load_dwordx4 v[108:111], v4, s[48:51], s95 offen offset:0 nt
    s_add_u32 s95, s79, 0
    buffer_load_dwordx4 v[112:115], v4, s[48:51], s95 offen offset:2048 nt
    s_add_u32 s95, s79, 16384
    buffer_load_dwordx4 v[116:119], v4, s[48:51], s95 offen offset:2048 nt
    s_add_u32 s95, s79, 32768
    buffer_load_dwordx4 v[120:123], v4, s[48:51], s95 offen offset:2048 nt
    s_add_u32 s95, s79, 49152
    buffer_load_dwordx4 v[124:127], v4, s[48:51], s95 offen offset:2048 nt
    s_lshl_b32 s31, s30, 10
    s_add_u32 s31, s31, 0x280000
    s_waitcnt vmcnt(8)
    s_mov_b32 s87, 0
L_POLLH:
    v_perm_b32 v8, v145, v144, s92
    v_perm_b32 v9, v147, v146, s93
    v_or_b32 v10, v8, v9
    v_xor_b32 v10, s56, v10
    v_perm_b32 v8, v149, v148, s92
    v_perm_b32 v9, v151, v150, s93
    v_or_b32 v8, v8, v9
    v_xor_b32 v8, s56, v8
    v_or_b32 v10, v10, v8
    v_cmp_ne_u32 vcc, 0, v10
    s_nop 3
    s_cbranch_vccz L_POLLH_DONE
    s_add_u32 s87, s87, 1
    s_cmp_gt_u32 s87, 0x20000
    s_cbranch_scc1 L_POLLH_DONE
    buffer_load_dwordx4 v[144:147], v30, s[52:55], s85 offen sc1
    buffer_load_dwordx4 v[148:151], v30, s[52:55], s85 offen offset:16 sc1
    s_waitcnt vmcnt(0)
    s_branch L_POLLH
L_POLLH_DONE:
    v_add_f32_dpp v144, v144, v144 row_ror:2 row_mask:0xf bank_mask:0xf
    v_add_f32_dpp v145, v145, v145 row_ror:2 row_mask:0xf bank_mask:0xf
    v_add_f32_dpp v146, v146, v146 row_ror:2 row_mask:0xf bank_mask:0xf
    v_add_f32_dpp v147, v147, v147 row_ror:2 row_mask:0xf bank_mask:0xf
    v_add_f32_dpp v148, v148, v148 row_ror:2 row_mask:0xf bank_mask:0xf
    v_add_f32_dpp v149, v149, v149 row_ror:2 row_mask:0xf bank_mask:0xf
    v_add_f32_dpp v150, v150, v150 row_ror:2 row_mask:0xf bank_mask:0xf
    v_add_f32_dpp v151, v151, v151 row_ror:2 row_mask:0xf bank_mask:0xf
    v_add_f32_dpp v144, v144, v144 row_ror:4 row_mask:0xf bank_mask:0xf
    v_add_f32_dpp v145, v145, v145 row_ror:4 row_mask:0xf bank_mask:0xf
    v_add_f32_dpp v146, v146, v146 row_ror:4 row_mask:0xf bank_mask:0xf
    v_add_f32_dpp v147, v147, v147 row_ror:4 row_mask:0xf bank_mask:0xf
    v_add_f32_dpp v148, v148, v148 row_ror:4 row_mask:0xf bank_mask:0xf
    v_add_f32_dpp v149, v149, v149 row_ror:4 row_mask:0xf bank_mask:0xf
    v_add_f32_dpp v150, v150, v150 row_ror:4 row_mask:0xf bank_mask:0xf
    v_add_f32_dpp v151, v151, v151 row_ror:4 row_mask:0xf bank_mask:0xf
    v_cvt_pk_bf16_f32 v8, v144, v148
    v_cvt_pk_bf16_f32 v9, v145, v149
    v_cvt_pk_bf16_f32 v10, v146, v150
    v_cvt_pk_bf16_f32 v11, v147, v151
    v_lshlrev_b32 v144, 16, v8
    v_and_b32 v148, s90, v8
    v_lshlrev_b32 v12, 16, v152
    v_and_b32 v16, s90, v152
    v_lshlrev_b32 v145, 16, v9
    v_and_b32 v149, s90, v9
    v_lshlrev_b32 v13, 16, v153
    v_and_b32 v17, s90, v153
    v_lshlrev_b32 v146, 16, v10
    v_and_b32 v150, s90, v10
    v_lshlrev_b32 v14, 16, v154
    v_and_b32 v18, s90, v154
    v_lshlrev_b32 v147, 16, v11
    v_and_b32 v151, s90, v11
    v_lshlrev_b32 v15, 16, v155
    v_and_b32 v19, s90, v155
    v_add_f32 v144, v144, v12
    v_add_f32 v145, v145, v13
    v_add_f32 v146, v146, v14
    v_add_f32 v147, v147, v15
    v_add_f32 v148, v148, v16
    v_add_f32 v149, v149, v17
    v_add_f32 v150, v150, v18
    v_add_f32 v151, v151, v19
    v_cvt_pk_bf16_f32 v8, v144, v148
    v_cvt_pk_bf16_f32 v9, v145, v149
    v_cvt_pk_bf16_f32 v10, v146, v150
    v_cvt_pk_bf16_f32 v11, v147, v151
    v_lshlrev_b32 v144, 16, v8
    v_and_b32 v148, s90, v8
    v_lshlrev_b32 v145, 16, v9
    v_and_b32 v149, s90, v9
    v_lshlrev_b32 v146, 16, v10
    v_and_b32 v150, s90, v10
    v_lshlrev_b32 v147, 16, v11
    v_and_b32 v151, s90, v11
    v_cmp_gt_f32 vcc, v144, 0
    s_nop 1
    v_cndmask_b32 v144, 0, v144, vcc
    v_cmp_gt_f32 vcc, v145, 0
    s_nop 1
    v_cndmask_b32 v145, 0, v145, vcc
    v_cmp_gt_f32 vcc, v146, 0
    s_nop 1
    v_cndmask_b32 v146, 0, v146, vcc
    v_cmp_gt_f32 vcc, v147, 0
    s_nop 1
    v_cndmask_b32 v147, 0, v147, vcc
    v_cmp_gt_f32 vcc, v148, 0
    s_nop 1
    v_cndmask_b32 v148, 0, v148, vcc
    v_cmp_gt_f32 vcc, v149, 0
    s_nop 1
    v_cndmask_b32 v149, 0, v149, vcc
    v_cmp_gt_f32 vcc, v150, 0
    s_nop 1
    v_cndmask_b32 v150, 0, v150, vcc
    v_cmp_gt_f32 vcc, v151, 0
    s_nop 1
    v_cndmask_b32 v151, 0, v151, vcc
    v_mul_f32 v144, v144, v144
    v_mul_f32 v145, v145, v145
    v_mul_f32 v146, v146, v146
    v_mul_f32 v147, v147, v147
    v_mul_f32 v148, v148, v148
    v_mul_f32 v149, v149, v149
    v_mul_f32 v150, v150, v150
    v_mul_f32 v151, v151, v151
    v_cvt_pk_bf16_f32 v24, v144, v145
    v_cvt_pk_bf16_f32 v25, v146, v147
    v_cvt_pk_bf16_f32 v26, v148, v149
    v_cvt_pk_bf16_f32 v27, v150, v151
    v_lshlrev_b32 v29, 9, v5
    v_lshl_add_u32 v29, v6, 7, v29
    s_lshl_b32 s74, s72, 10
    v_add_u32 v29, s74, v29
    s_waitcnt vmcnt(0)
    v_perm_b32 v8, v100, v96, s77
    v_perm_b32 v9, v108, v104, s77
    v_perm_b32 v10, v116, v112, s77
    v_perm_b32 v11, v124, v120, s77
    v_perm_b32 v12, v100, v96, s78
    v_perm_b32 v13, v108, v104, s78
    v_perm_b32 v14, v116, v112, s78
    v_perm_b32 v15, v124, v120, s78
    v_mfma_f32_16x16x32_bf16 v[224:227], v[8:11], v[24:27], 0
    v_perm_b32 v16, v101, v97, s77
    v_perm_b32 v17, v109, v105, s77
    v_perm_b32 v18, v117, v113, s77
    v_perm_b32 v19, v125, v121, s77
    v_mfma_f32_16x16x32_bf16 v[228:231], v[12:15], v[24:27], 0
    v_perm_b32 v20, v101, v97, s78
    v_perm_b32 v21, v109, v105, s78
    v_perm_b32 v22, v117, v113, s78
    v_perm_b32 v23, v125, v121, s78
    v_mfma_f32_16x16x32_bf16 v[232:235], v[16:19], v[24:27], 0
    v_perm_b32 v8, v102, v98, s77
    v_perm_b32 v9, v110, v106, s77
    v_perm_b32 v10, v118, v114, s77
    v_perm_b32 v11, v126, v122, s77
    v_mfma_f32_16x16x32_bf16 v[236:239], v[20:23], v[24:27], 0
    v_perm_b32 v12, v102, v98, s78
    v_perm_b32 v13, v110, v106, s78
    v_perm_b32 v14, v118, v114, s78
    v_perm_b32 v15, v126, v122, s78
    v_mfma_f32_16x16x32_bf16 v[240:243], v[8:11], v[24:27], 0
    v_perm_b32 v16, v103, v99, s77
    v_perm_b32 v17, v111, v107, s77
    v_perm_b32 v18, v119, v115, s77
    v_perm_b32 v19, v127, v123, s77
    v_mfma_f32_16x16x32_bf16 v[244:247], v[12:15], v[24:27], 0
    v_perm_b32 v20, v103, v99, s78
    v_perm_b32 v21, v111, v107, s78
    v_perm_b32 v22, v119, v115, s78
    v_perm_b32 v23, v127, v123, s78
    v_mfma_f32_16x16x32_bf16 v[248:251], v[16:19], v[24:27], 0
    s_nop 0
    v_mfma_f32_16x16x32_bf16 v[252:255], v[20:23], v[24:27], 0
    s_mov_b64 exec, s[80:81]
    ds_write_b128 v29, v[224:227] offset:0
    ds_write_b128 v29, v[228:231] offset:16
    ds_write_b128 v29, v[232:235] offset:32
    ds_write_b128 v29, v[236:239] offset:48
    ds_write_b128 v29, v[240:243] offset:64
    ds_write_b128 v29, v[244:247] offset:80
    ds_write_b128 v29, v[248:251] offset:96
    ds_write_b128 v29, v[252:255] offset:112
    s_mov_b64 exec, -1
    v_lshrrev_b32 v28, 1, v0
    v_lshlrev_b32 v28, 13, v28
    v_and_b32 v29, 1, v0
    v_lshl_add_u32 v28, v29, 4, v28
    s_and_b32 s74, s2, 7
    s_lshl_b32 s74, s74, 10
    s_lshl_b32 s75, s94, 5
    s_add_u32 s74, s74, s75
    s_add_u32 s75, s74, 0x280000
    s_add_u32 s74, s74, 0x300000
    s_add_u32 s95, s74, 0x40000
    s_add_u32 s84, s74, 0x80000
    s_add_u32 s85, s74, 0xc0000
    s_mov_b32 s87, 0
    v_lshlrev_b32 v156, 16, v156
    v_lshlrev_b32 v157, 16, v157
    s_mov_b32 s98, 0xff00ff00
    s_mov_b32 s99, 0xff00ff00
    s_waitcnt lgkmcnt(0)
    s_barrier
    s_cmp_eq_u32 s72, 7
    s_cbranch_scc1 L_FIN
    s_cmp_lg_u32 s72, 4
    s_cbranch_scc1 L_DONE
    ds_read_b128 v[160:163], v2 offset:4096
    ds_read_b128 v[164:167], v2 offset:5120
    ds_read_b128 v[168:171], v2 offset:6144
    ds_read_b128 v[172:175], v2 offset:7168
    s_waitcnt lgkmcnt(0)
    v_pk_add_f32 v[160:161], v[160:161], v[168:169]
    v_pk_add_f32 v[162:163], v[162:163], v[170:171]
    v_pk_add_f32 v[164:165], v[164:165], v[172:173]
    v_pk_add_f32 v[166:167], v[166:167], v[174:175]
    v_pk_add_f32 v[160:161], v[160:161], v[164:165]
    v_pk_add_f32 v[162:163], v[162:163], v[166:167]
    v_bfi_b32 v160, v3, s56, v160
    v_bfi_b32 v161, v3, s57, v161
    v_bfi_b32 v162, v3, s58, v162
    v_bfi_b32 v163, v3, s59, v163
    buffer_store_dwordx4 v[160:163], v2, s[52:55], s31 offen sc1
    s_nop 0
    s_branch L_DONE
L_FIN:
    s_movk_i32 s30, 64
L_POLL2:
    buffer_load_dwordx4 v[160:163], v28, s[52:55], s74 offen sc1
    buffer_load_dwordx4 v[164:167], v28, s[52:55], s95 offen sc1
    buffer_load_dwordx4 v[168:171], v28, s[52:55], s84 offen sc1
    buffer_load_dwordx4 v[172:175], v28, s[52:55], s85 offen sc1
    buffer_load_dwordx4 v[176:179], v28, s[52:55], s75 offen sc1
    s_mov_b64 exec, -1
    s_add_u32 s87, s87, 1
    s_cmp_gt_u32 s30, 32
    s_nop 1
    s_cbranch_scc1 L_P2S
    s_waitcnt vmcnt(35)
    s_branch L_P2C
L_P2S:
    s_waitcnt vmcnt(0)
L_P2C:
    v_perm_b32 v8, v161, v160, s92
    v_perm_b32 v9, v163, v162, s93
    v_or_b32 v10, v8, v9
    v_xor_b32 v10, s56, v10
    v_perm_b32 v8, v165, v164, s92
    v_perm_b32 v9, v167, v166, s93
    v_or_b32 v8, v8, v9
    v_xor_b32 v8, s56, v8
    v_or_b32 v10, v10, v8
    v_perm_b32 v8, v169, v168, s92
    v_perm_b32 v9, v171, v170, s93
    v_or_b32 v8, v8, v9
    v_xor_b32 v8, s56, v8
    v_or_b32 v10, v10, v8
    v_perm_b32 v8, v173, v172, s92
    v_perm_b32 v9, v175, v174, s93
    v_or_b32 v8, v8, v9
    v_xor_b32 v8, s56, v8
    v_or_b32 v10, v10, v8
    v_perm_b32 v8, v177, v176, s92
    v_perm_b32 v9, v179, v178, s93
    v_or_b32 v8, v8, v9
    v_xor_b32 v8, s56, v8
    v_or_b32 v10, v10, v8
    v_cmp_ne_u32 vcc, 0, v10
    s_cmp_gt_u32 s87, 0x40000
    s_nop 2
    s_cbranch_scc1 L_POLL2_DONE
    s_cbranch_vccz L_POLL2_DONE
    s_bcnt1_i32_b64 s30, vcc
    s_mov_b64 exec, vcc
    s_nop 3
    s_branch L_POLL2
L_POLL2_DONE:
    v_pk_add_f32 v[224:225], v[160:161], v[164:165]
    v_pk_add_f32 v[226:227], v[162:163], v[166:167]
    v_pk_add_f32 v[232:233], v[168:169], v[172:173]
    v_pk_add_f32 v[234:235], v[170:171], v[174:175]
    v_mov_b64 v[240:241], v[176:177]
    v_mov_b64 v[242:243], v[178:179]
    v_pk_add_f32 v[224:225], v[224:225], v[232:233]
    v_pk_add_f32 v[226:227], v[226:227], v[234:235]
    s_nop 0
    v_permlane32_swap_b32 v224, v240
    v_permlane32_swap_b32 v225, v241
    v_permlane32_swap_b32 v226, v242
    v_permlane32_swap_b32 v227, v243
    v_pk_add_f32 v[224:225], v[224:225], v[240:241]
    v_pk_add_f32 v[226:227], v[226:227], v[242:243]
    s_nop 0
    v_permlane16_swap_b32 v224, v225
    v_permlane16_swap_b32 v226, v227
    v_add_f32 v224, v224, v225
    v_add_f32 v226, v226, v227
    s_nop 0
    v_add_f32_dpp v224, v224, v224 row_ror:2 row_mask:0xf bank_mask:0xf
    v_add_f32_dpp v226, v226, v226 row_ror:2 row_mask:0xf bank_mask:0xf
    s_nop 0
    v_add_f32_dpp v224, v224, v224 row_ror:4 row_mask:0xf bank_mask:0xf
    v_add_f32_dpp v226, v226, v226 row_ror:4 row_mask:0xf bank_mask:0xf
    s_nop 0
    v_add_f32_dpp v224, v224, v224 row_ror:8 row_mask:0xf bank_mask:0xf
    v_add_f32_dpp v226, v226, v226 row_ror:8 row_mask:0xf bank_mask:0xf
    v_cndmask_b32 v224, v224, v226, s[98:99]
    v_mov_b32 v225, v224
    s_nop 1
    v_permlane32_swap_b32 v224, v225
    v_cvt_pk_bf16_f32 v226, v224, v225
    v_lshlrev_b32 v224, 16, v226
    v_and_b32 v225, s90, v226
    v_add_f32 v224, v156, v224
    v_add_f32 v225, v225, v157
    v_cvt_pk_bf16_f32 v226, v224, v225
    v_lshlrev_b32 v224, 16, v226
    v_and_b32 v225, s90, v226
    v_add_f32 v224, v224, v225
    v_cvt_pk_bf16_f32 v224, v224, v224
    s_mov_b64 exec, 0x03030303
    buffer_store_short v224, v158, s[60:63], s86 offen
    s_cmp_lg_u32 s2, 0
    s_nop 1
    s_cbranch_scc1 L_DONE
    s_mov_b64 exec, 1
    v_mov_b32 v28, s91
    s_mov_b32 s74, 0x90000
    buffer_store_dword v28, off, s[52:55], s74 sc1
L_DONE:
L_END:
s_endpgm
.section .rodata,"a"
.p2align 6
.amdhsa_kernel parallel_sum__gqa_block_cached__dense_activation_squared_relu__decode_kernel
  .amdhsa_next_free_vgpr 256
  .amdhsa_next_free_sgpr 102
  .amdhsa_accum_offset 256
  .amdhsa_group_segment_fixed_size 0
  .amdhsa_kernarg_size 104
  .amdhsa_user_sgpr_count 2
  .amdhsa_user_sgpr_kernarg_segment_ptr 1
  .amdhsa_system_sgpr_workgroup_id_x 1
.end_amdhsa_kernel
```
